```python
import torch

def _softmax(x, axis=-1):
    return torch.softmax(x, dim=axis)
def _gelu(x):
    return torch.nn.functional.gelu(x, approximate="tanh")
def _silu(x):
    return torch.nn.functional.silu(x)
def _sigmoid(x):
    return torch.sigmoid(x)
def _layernorm(x, axis=-1, eps=1e-5):
    m = x.mean(dim=axis, keepdim=True)
    v = x.var(dim=axis, keepdim=True, unbiased=False)
    return (x - m) / torch.sqrt(v + eps)
def _scatter_add(tgt, idx, src, axis=0):
    return tgt.clone().index_add_(axis, idx, src)
def _segment_sum(src, seg, n):
    out = torch.zeros((n,) + src.shape[1:], dtype=src.dtype)
    return out.index_add_(0, seg, src)
def _pad(x, pw):
    flat = tuple(v for pair in reversed(pw) for v in pair)
    return torch.nn.functional.pad(x, flat)

kernel_name = 'parallel_sum__spectral_gfnet__glu_gated_reglu__prompt'

def setup_inputs():

    _w = (lambda a: (lambda t: t.to(torch.bfloat16) if t.is_floating_point() else t)(torch.as_tensor(a)))
    def _A_setup():
        B, S, D = 1, 2048, 512
        Df = D // 2 + 1
        return {
            "x": _w((lambda *s: torch.randn(*s, dtype=torch.bfloat16) * 0.05)(B, S, D)),
            "w_r": _w((lambda *s: torch.randn(*s, dtype=torch.bfloat16) * 0.4)(S, Df) * 0.02),
            "w_i": _w((lambda *s: torch.randn(*s, dtype=torch.bfloat16) * 0.4)(S, Df) * 0.02),
        }
    _A_in = _A_setup()

    def _B_setup():
        B, S, D, F = 1, 2048, 512, 1792
        return {
            "x": _w((lambda *s: torch.randn(*s, dtype=torch.bfloat16) * 0.05)(B, S, D)),
            "W_gate": _w((lambda *s: torch.randn(*s, dtype=torch.bfloat16) * 0.2)(D, F) * (2.0 / D) ** 0.5),
            "W_up": _w((lambda *s: torch.randn(*s, dtype=torch.bfloat16) * 0.2)(D, F) * (2.0 / D) ** 0.5),
            "W_down": _w((lambda *s: torch.randn(*s, dtype=torch.bfloat16) * 0.2)(F, D) * (1.0 / F) ** 0.5),
        }
    _B_in = _B_setup()

    return {
        "A_x": _A_in["x"],
        "A_w_r": _A_in["w_r"],
        "A_w_i": _A_in["w_i"],
        "B_x": _B_in["x"],
        "B_W_gate": _B_in["W_gate"],
        "B_W_up": _B_in["W_up"],
        "B_W_down": _B_in["W_down"],
    }

def reference(A_x, A_w_r, A_w_i, B_x, B_W_gate, B_W_up, B_W_down):
    def _A_ref(x, w_r, w_i):
        B, S, D = x.shape
        X = (lambda x, axes=(-2,-1): torch.fft.rfft2(x.float(), dim=axes))(x, axes=(-2, -1))
        W = w_r + 1j * w_i
        X = X * W
        y = (lambda x, s, axes=(-2,-1): torch.fft.irfft2(x, s=s, dim=axes).to(torch.bfloat16))(X, (S, D), axes=(-2, -1))
        return y

    def _B_ref(x, W_gate, W_up, W_down):
        gate = torch.einsum("bsd,df->bsf", x, W_gate)
        up = torch.einsum("bsd,df->bsf", x, W_up)
        gate = gate * (lambda x, dt: x.to(dt))(gate > 0, gate.dtype)
        h = gate * up
        return torch.einsum("bsf,fd->bsd", h, W_down)

    x = A_x
    xn = _layernorm(x, axis=-1)
    return x + _A_ref(xn, A_w_r, A_w_i) + _B_ref(xn, B_W_gate, B_W_up, B_W_down)
```

```asm
; @launch kernel=k1_kernel grid=(256,1,1) block=(512,1,1) lds=163840
; @launch kernel=k23_kernel grid=(256,1,1) block=(512,1,1) lds=123136
.amdgcn_target "amdgcn-amd-amdhsa--gfx950"
.text
.globl k1_kernel
.p2align 8
.type k1_kernel,@function
k1_kernel:
  s_cmp_ge_u32 s2, 256
  s_cbranch_scc1 k1_kernel_done
  s_load_dwordx2 s[60:61], s[0:1], 0
  s_load_dwordx4 s[64:67], s[0:1], 32
  s_load_dwordx2 s[62:63], s[0:1], 72
  s_load_dwordx4 s[68:71], s[0:1], 8
  s_load_dwordx4 s[72:75], s[0:1], 48
  s_load_dwordx2 s[36:37], s[0:1], 64
  v_lshrrev_b32 v4, 6, v0
  v_and_b32 v1, 63, v0
  v_readfirstlane_b32 s42, v4
  s_bfe_u32 s40, s2, 0x10002
  s_lshl_b32 s40, s40, 3
  s_bfe_u32 s50, s2, 0x30003
  s_add_u32 s40, s40, s50
  s_lshr_b32 s41, s2, 6
  s_add_u32 s50, s41, 1
  s_lshr_b32 s50, s50, 2
  s_and_b32 s50, s50, s40
  s_lshl_b32 s50, s50, 1
  s_xor_b32 s50, s50, s2
  s_and_b32 s50, s50, 3
  s_lshl_b32 s41, s41, 2
  s_add_u32 s41, s41, s50
  s_sub_u32 s48, s41, 14
  s_lshl_b32 s48, s48, 9
  s_add_u32 s49, s48, 256
  s_lshl_b32 s50, s41, 8
  s_movk_i32 s45, 3584
  s_cmp_ge_u32 s41, 14
  s_cselect_b32 s45, 1152, s45
  s_cselect_b32 s46, s48, s50
  s_cselect_b32 s47, s49, s50
  s_lshl_b32 s55, s45, 2
  s_lshl_b32 s56, s45, 6
  s_getpc_b64 s[76:77]
  s_add_u32 s76, s76, ftab@rel32@lo+4
  s_addc_u32 s77, s77, ftab@rel32@hi+12
  v_lshrrev_b32 v4, 3, v1
  v_and_b32 v5, 7, v1
  v_lshrrev_b32 v6, 4, v1
  v_xor_b32 v5, v5, v6
  v_lshlrev_b32 v5, 4, v5
  v_lshl_add_u32 v5, v4, 16, v5
  s_and_b32 s48, s42, 1
  s_lshl_b32 s48, s48, 20
  s_lshr_b32 s49, s42, 1
  s_lshl_b32 s49, s49, 10
  s_add_u32 s48, s48, s49
  s_lshl_b32 s49, s40, 12
  s_add_u32 s48, s48, s49
  v_add_u32 v12, s48, v5
  v_xor_b32 v5, 0x80040, v5
  v_add_u32 v13, s48, v5
  v_lshlrev_b32 v7, 6, v6
  v_and_b32 v5, 15, v1
  v_lshlrev_b32 v5, 4, v5
  v_xor_b32 v5, v5, v7
  s_lshl_b32 s48, s42, 3
  v_add_u32 v4, s48, v6
  v_mul_lo_u32 v4, v4, s45
  v_add3_u32 v14, v4, v5, s46
  v_xor_b32 v5, 32, v5
  v_add3_u32 v15, v4, v5, s47
  s_lshl_b32 s57, s42, 11
  s_lshl_b32 s48, s41, 3
  s_add_u32 s48, s48, s42
  s_and_b32 s49, s48, 31
  s_lshl_b32 s49, s49, 16
  s_lshr_b32 s48, s48, 5
  s_lshl_b32 s48, s48, 10
  s_add_u32 s49, s49, s48
  s_lshl_b32 s48, s40, 12
  s_add_u32 s51, s49, s48
  v_lshlrev_b32 v5, 4, v1
  s_and_b32 s48, s40, 3
  s_lshl_b32 s48, s48, 1
  s_lshl_b32 s52, s48, 7
  s_mul_i32 s53, s48, s56
  s_mov_b32 s6, 2097152
  s_mov_b32 s7, 0x00020000
  s_mov_b32 s11, 0x00020000
  s_mov_b32 s15, 0x00020000
  s_lshl_b32 s10, s45, 9
  s_lshl_b32 s14, s45, 9
  s_waitcnt lgkmcnt(0)
  s_mov_b32 s4, s60
  s_and_b32 s5, s61, 0xffff
  s_cmp_ge_u32 s41, 14
  s_cselect_b32 s8, s76, s64
  s_cselect_b32 s9, s77, s65
  s_cselect_b32 s12, s76, s66
  s_cselect_b32 s13, s77, s67
  s_and_b32 s9, s9, 0xffff
  s_and_b32 s13, s13, 0xffff
  s_add_u32 m0, s57, 0
  s_and_b32 s52, s52, 1023
  buffer_load_dwordx4 v12, s[4:7], s52 offen lds
  s_add_u32 m0, s57, 1024
  s_nop 0
  buffer_load_dwordx4 v13, s[4:7], s52 offen lds
  s_add_u32 s52, s52, 128
  s_add_u32 m0, s57, 65536
  s_add_u32 s54, s53, s55
  buffer_load_dwordx4 v14, s[8:11], s53 offen lds
  s_add_u32 m0, s57, 114688
  s_nop 0
  buffer_load_dwordx4 v15, s[12:15], s53 offen lds
  s_add_u32 m0, s57, 66560
  s_add_u32 s53, s53, s56
  buffer_load_dwordx4 v14, s[8:11], s54 offen lds
  s_add_u32 m0, s57, 115712
  s_nop 0
  buffer_load_dwordx4 v15, s[12:15], s54 offen lds
  s_cmp_ge_u32 s53, s10
  s_cselect_b32 s53, 0, s53
  v_add_u32 v20, s51, v5
  s_barrier
  v_and_b32 v2, 31, v1
  v_lshrrev_b32 v3, 5, v1
  s_and_b32 s43, s42, 3
  s_lshr_b32 s44, s42, 2
  v_bfe_u32 v4, v2, 1, 3
  v_xor_b32 v4, v4, v3
  s_lshl_b32 s48, s44, 13
  v_lshlrev_b32 v5, 7, v2
  v_add_u32 v5, s48, v5
  v_lshl_add_u32 v16, v4, 4, v5
  s_add_u32 m0, s57, 16384
  s_and_b32 s52, s52, 1023
  buffer_load_dwordx4 v12, s[4:7], s52 offen lds
  v_xor_b32 v17, 32, v16
  v_xor_b32 v18, 64, v16
  v_xor_b32 v19, 96, v16
  s_add_u32 m0, s57, 17408
  s_nop 0
  buffer_load_dwordx4 v13, s[4:7], s52 offen lds
  s_add_u32 s52, s52, 128
  v_bfe_u32 v6, v1, 4, 1
  v_bfe_u32 v7, v1, 2, 2
  v_lshl_add_u32 v8, v7, 1, v6
  s_lshl_b32 s58, s43, 1
  s_add_u32 s58, s58, s44
  v_xor_b32 v8, s58, v8
  s_add_u32 m0, s57, 81920
  s_add_u32 s54, s53, s55
  buffer_load_dwordx4 v14, s[8:11], s53 offen lds
  v_lshlrev_b32 v8, 5, v8
  v_lshl_add_u32 v8, v7, 8, v8
  v_and_b32 v7, 3, v1
  v_lshl_add_u32 v8, v7, 3, v8
  v_lshl_add_u32 v8, v3, 11, v8
  s_add_u32 m0, s57, 131072
  s_nop 0
  buffer_load_dwordx4 v15, s[12:15], s53 offen lds
  v_mul_u32_u24 v6, 49152, v6
  v_add_u32 v8, v8, v6
  v_add_u32 v21, 65536, v8
  v_xor_b32 v22, 32, v21
  s_add_u32 m0, s57, 82944
  s_add_u32 s53, s53, s56
  buffer_load_dwordx4 v14, s[8:11], s54 offen lds
  v_bfe_u32 v6, v1, 4, 1
  v_cmp_eq_u32 vcc, v7, v6
  v_mov_b32 v6, 0x3f803f80
  v_mov_b32 v7, 0
  s_add_u32 m0, s57, 132096
  s_nop 0
  buffer_load_dwordx4 v15, s[12:15], s54 offen lds
  s_cmp_ge_u32 s53, s10
  s_cselect_b32 s53, 0, s53
  v_cndmask_b32 v60, v7, v6, vcc
  v_cndmask_b32 v61, v7, v6, vcc
  v_cndmask_b32 v62, v7, v6, vcc
  v_cndmask_b32 v63, v7, v6, vcc
  s_barrier
  buffer_load_dwordx4 v[64:67], v20, s[4:7], 0 offen
  s_add_u32 m0, s57, 32768
  s_and_b32 s52, s52, 1023
  buffer_load_dwordx4 v12, s[4:7], s52 offen lds
  s_add_u32 m0, s57, 33792
  s_nop 0
  buffer_load_dwordx4 v13, s[4:7], s52 offen lds
  s_add_u32 s52, s52, 128
  s_mov_b32 s16, s62
  s_and_b32 s17, s63, 0xffff
  s_mov_b32 s18, 18874368
  s_mov_b32 s19, 0x00020000
  s_mov_b32 s20, s68
  s_and_b32 s21, s69, 0xffff
  s_mov_b32 s22, 1052672
  s_mov_b32 s23, 0x00020000
  s_mov_b32 s24, s70
  s_and_b32 s25, s71, 0xffff
  s_mov_b32 s26, 1052672
  s_mov_b32 s27, 0x00020000
  s_mov_b32 s28, s72
  s_and_b32 s29, s73, 0xffff
  s_mov_b32 s30, 1835008
  s_mov_b32 s31, 0x00020000
  s_mov_b32 s36, s36
  s_and_b32 s37, s37, 0xffff
  s_mov_b32 s38, 256
  s_mov_b32 s39, 0x00020000
  s_or_b32 s48, s42, s2
  s_cmp_lg_u32 s48, 0
  s_cbranch_scc1 k1_kernel_nonon
  s_memrealtime s[64:65]
  s_waitcnt lgkmcnt(0)
  s_or_b32 s64, s64, 1
  v_mov_b32 v4, s64
  v_mov_b32 v5, 0
  s_mov_b64 exec, 1
  buffer_store_dword v4, v5, s[36:39], 0 offen sc1
  s_mov_b64 exec, -1
k1_kernel_nonon:
  s_lshl_b32 s48, s2, 3
  s_add_u32 s48, s48, s42
  s_lshl_b32 s48, s48, 10
  s_add_u32 s48, s48, 13631488
  v_lshlrev_b32 v11, 4, v1
  v_mov_b32 v204, -1
  v_mov_b32 v205, -1
  v_mov_b32 v206, -1
  v_mov_b32 v207, -1
  buffer_store_dwordx4 v[204:207], v11, s[16:19], s48 offen sc1
  s_cmp_lt_u32 s41, 14
  s_cselect_b64 vcc, -1, 0
  s_waitcnt vmcnt(10)
  s_barrier
  ds_read_b64_tr_b16 v[88:89], v21 offset:0
  ds_read_b64_tr_b16 v[90:91], v21 offset:1024
  ds_read_b128 v[72:75], v16 offset:0
  ds_read_b64_tr_b16 v[92:93], v22 offset:0
  ds_read_b64_tr_b16 v[94:95], v22 offset:1024
  ds_read_b128 v[76:79], v16 offset:4096
  s_waitcnt lgkmcnt(0)
  s_cbranch_vccz k1_kernel_sk1
  v_mfma_f32_16x16x32_bf16 v[52:55], v[60:63], v[88:91], 0
k1_kernel_sk1:
  ds_read_b64_tr_b16 v[96:97], v21 offset:4096
  ds_read_b64_tr_b16 v[98:99], v21 offset:5120
  ds_read_b128 v[80:83], v17 offset:0
  ds_read_b64_tr_b16 v[100:101], v22 offset:4096
  ds_read_b64_tr_b16 v[102:103], v22 offset:5120
  ds_read_b128 v[84:87], v17 offset:4096
  v_mfma_f32_32x32x16_bf16 v[104:119], v[88:91], v[72:75], 0
  s_waitcnt vmcnt(3)
  s_add_u32 m0, s57, 98304
  s_add_u32 s54, s53, s55
  buffer_load_dwordx4 v14, s[8:11], s53 offen lds
  v_lshlrev_b32 v168, 16, v64
  v_and_b32 v169, 0xffff0000, v64
  v_lshlrev_b32 v170, 16, v65
  v_and_b32 v171, 0xffff0000, v65
  v_mfma_f32_32x32x16_bf16 v[136:151], v[92:95], v[72:75], 0
  v_lshlrev_b32 v172, 16, v66
  v_and_b32 v173, 0xffff0000, v66
  v_lshlrev_b32 v174, 16, v67
  v_and_b32 v175, 0xffff0000, v67
  v_add_f32 v4, v168, v169
  v_mfma_f32_32x32x16_bf16 v[120:135], v[88:91], v[76:79], 0
  s_add_u32 m0, s57, 147456
  s_nop 0
  buffer_load_dwordx4 v15, s[12:15], s53 offen lds
  v_add_f32 v5, v170, v171
  v_add_f32 v6, v172, v173
  v_add_f32 v7, v174, v175
  v_add_f32 v4, v4, v5
  v_mfma_f32_32x32x16_bf16 v[152:167], v[92:95], v[76:79], 0
  v_add_f32 v6, v6, v7
  v_add_f32 v4, v4, v6
  s_nop 1
  v_add_f32_dpp v4, v4, v4 quad_perm:[1,0,3,2] row_mask:0xf bank_mask:0xf
  s_nop 1
  s_waitcnt lgkmcnt(0)
  s_cbranch_vccz k1_kernel_sk2
  v_mfma_f32_16x16x32_bf16 v[52:55], v[60:63], v[96:99], v[52:55]
k1_kernel_sk2:
  ds_read_b64_tr_b16 v[88:89], v21 offset:8192
  ds_read_b64_tr_b16 v[90:91], v21 offset:9216
  ds_read_b128 v[72:75], v18 offset:0
  ds_read_b64_tr_b16 v[92:93], v22 offset:8192
  ds_read_b64_tr_b16 v[94:95], v22 offset:9216
  ds_read_b128 v[76:79], v18 offset:4096
  v_mfma_f32_32x32x16_bf16 v[104:119], v[96:99], v[80:83], v[104:119]
  v_add_f32_dpp v4, v4, v4 quad_perm:[2,3,0,1] row_mask:0xf bank_mask:0xf
  s_add_u32 m0, s57, 99328
  s_add_u32 s53, s53, s56
  buffer_load_dwordx4 v14, s[8:11], s54 offen lds
  s_nop 1
  v_add_f32_dpp v4, v4, v4 row_half_mirror row_mask:0xf bank_mask:0xf
  s_nop 1
  v_add_f32_dpp v4, v4, v4 row_mirror row_mask:0xf bank_mask:0xf
  v_mfma_f32_32x32x16_bf16 v[136:151], v[100:103], v[80:83], v[136:151]
  v_mov_b32 v7, v4
  s_nop 1
  v_permlane16_swap_b32 v4, v7
  v_add_f32 v4, v4, v7
  v_mov_b32 v7, v4
  s_nop 1
  v_mfma_f32_32x32x16_bf16 v[120:135], v[96:99], v[84:87], v[120:135]
  s_add_u32 m0, s57, 148480
  s_nop 0
  buffer_load_dwordx4 v15, s[12:15], s54 offen lds
  s_cmp_ge_u32 s53, s10
  s_cselect_b32 s53, 0, s53
  v_permlane32_swap_b32 v4, v7
  v_add_f32 v4, v4, v7
  v_mul_f32 v4, 0x3b000000, v4
  v_cvt_pk_bf16_f32 v24, -v4, -v4
  v_mfma_f32_32x32x16_bf16 v[152:167], v[100:103], v[84:87], v[152:167]
  v_sub_f32 v168, v168, v4
  v_mov_b32 v70, 0
  buffer_load_dword v68, v70, s[36:39], 0 offen sc1
  v_sub_f32 v169, v169, v4
  v_sub_f32 v170, v170, v4
  v_sub_f32 v171, v171, v4
  s_waitcnt lgkmcnt(0)
  s_cbranch_vccz k1_kernel_sk3
  v_mfma_f32_16x16x32_bf16 v[52:55], v[60:63], v[88:91], v[52:55]
k1_kernel_sk3:
  ds_read_b64_tr_b16 v[96:97], v21 offset:12288
  ds_read_b64_tr_b16 v[98:99], v21 offset:13312
  ds_read_b128 v[80:83], v19 offset:0
  ds_read_b64_tr_b16 v[100:101], v22 offset:12288
  ds_read_b64_tr_b16 v[102:103], v22 offset:13312
  ds_read_b128 v[84:87], v19 offset:4096
  v_mfma_f32_32x32x16_bf16 v[104:119], v[88:91], v[72:75], v[104:119]
  v_sub_f32 v172, v172, v4
  s_add_u32 m0, s57, 49152
  s_and_b32 s52, s52, 1023
  buffer_load_dwordx4 v12, s[4:7], s52 offen lds
  v_sub_f32 v173, v173, v4
  v_sub_f32 v174, v174, v4
  v_sub_f32 v175, v175, v4
  v_mul_f32 v5, v168, v168
  v_mfma_f32_32x32x16_bf16 v[136:151], v[92:95], v[72:75], v[136:151]
  v_mul_f32 v6, v169, v169
  v_fmac_f32 v5, v170, v170
  v_fmac_f32 v6, v171, v171
  v_fmac_f32 v5, v172, v172
  v_fmac_f32 v6, v173, v173
  v_fmac_f32 v5, v174, v174
  v_mfma_f32_32x32x16_bf16 v[120:135], v[88:91], v[76:79], v[120:135]
  s_add_u32 m0, s57, 50176
  s_nop 0
  buffer_load_dwordx4 v13, s[4:7], s52 offen lds
  s_add_u32 s52, s52, 128
  v_fmac_f32 v6, v175, v175
  v_add_f32 v5, v5, v6
  s_nop 1
  v_add_f32_dpp v5, v5, v5 quad_perm:[1,0,3,2] row_mask:0xf bank_mask:0xf
  v_mfma_f32_32x32x16_bf16 v[152:167], v[92:95], v[76:79], v[152:167]
  s_nop 1
  v_add_f32_dpp v5, v5, v5 quad_perm:[2,3,0,1] row_mask:0xf bank_mask:0xf
  s_nop 1
  v_add_f32_dpp v5, v5, v5 row_half_mirror row_mask:0xf bank_mask:0xf
  s_nop 1
  s_waitcnt lgkmcnt(0)
  s_cbranch_vccz k1_kernel_sk4
  v_mfma_f32_16x16x32_bf16 v[52:55], v[60:63], v[96:99], v[52:55]
k1_kernel_sk4:
  v_add_f32_dpp v5, v5, v5 row_mirror row_mask:0xf bank_mask:0xf
  v_mov_b32 v7, v5
  s_nop 1
  v_permlane16_swap_b32 v5, v7
  v_add_f32 v5, v5, v7
  v_mov_b32 v7, v5
  s_nop 1
  v_mfma_f32_32x32x16_bf16 v[104:119], v[96:99], v[80:83], v[104:119]
  v_permlane32_swap_b32 v5, v7
  v_add_f32 v5, v5, v7
  v_mul_f32 v5, 0x3b000000, v5
  v_cvt_pk_bf16_f32 v7, v5, v5
  v_and_b32 v7, 0xffff0000, v7
  v_add_f32 v7, 0x3727c5ac, v7
  v_cvt_pk_bf16_f32 v7, v7, v7
  v_mfma_f32_32x32x16_bf16 v[136:151], v[100:103], v[80:83], v[136:151]
  v_and_b32 v7, 0xffff0000, v7
  v_sqrt_f32 v7, v7
  v_and_b32 v24, 0xffff, v24
  v_cvt_pk_bf16_f32 v7, v7, v7
  v_and_b32 v7, 0xffff0000, v7
  v_or_b32 v24, v24, v7
  s_barrier
  ds_read_b64_tr_b16 v[88:89], v21 offset:16384
  ds_read_b64_tr_b16 v[90:91], v21 offset:17408
  ds_read_b128 v[72:75], v16 offset:16384
  ds_read_b64_tr_b16 v[92:93], v22 offset:16384
  ds_read_b64_tr_b16 v[94:95], v22 offset:17408
  ds_read_b128 v[76:79], v16 offset:20480
  v_mfma_f32_32x32x16_bf16 v[120:135], v[96:99], v[84:87], v[120:135]
  v_mfma_f32_32x32x16_bf16 v[152:167], v[100:103], v[84:87], v[152:167]
  s_waitcnt lgkmcnt(0)
  s_cbranch_vccz k1_kernel_sk5
  v_mfma_f32_16x16x32_bf16 v[52:55], v[60:63], v[88:91], v[52:55]
k1_kernel_sk5:
  ds_read_b64_tr_b16 v[96:97], v21 offset:20480
  ds_read_b64_tr_b16 v[98:99], v21 offset:21504
  ds_read_b128 v[80:83], v17 offset:16384
  v_mfma_f32_32x32x16_bf16 v[104:119], v[88:91], v[72:75], v[104:119]
  ds_read_b64_tr_b16 v[100:101], v22 offset:20480
  ds_read_b64_tr_b16 v[102:103], v22 offset:21504
  ds_read_b128 v[84:87], v17 offset:20480
  v_mfma_f32_32x32x16_bf16 v[136:151], v[92:95], v[72:75], v[136:151]
  s_add_u32 m0, s57, 65536
  s_add_u32 s54, s53, s55
  buffer_load_dwordx4 v14, s[8:11], s53 offen lds
  v_mfma_f32_32x32x16_bf16 v[120:135], v[88:91], v[76:79], v[120:135]
  s_waitcnt vmcnt(3)
  s_mov_b32 s51, 16384
k1_kernel_nn:
  v_readfirstlane_b32 s64, v68
  s_cmp_lg_u32 s64, 0
  s_cbranch_scc1 k1_kernel_nnok
  s_sub_u32 s51, s51, 1
  s_cbranch_scc1 k1_kernel_nnok
  s_sleep 8
  buffer_load_dword v68, v70, s[36:39], 0 offen sc1
  s_waitcnt vmcnt(0)
  s_branch k1_kernel_nn
k1_kernel_nnok:
  s_lshl_b32 s48, s40, 7
  s_lshl_b32 s49, s41, 3
  s_add_u32 s48, s48, s49
  s_add_u32 s48, s48, s42
  s_lshl_b32 s48, s48, 3
  s_add_u32 s48, s48, 15728640
  v_mov_b32 v25, v68
  s_mov_b64 exec, 1
  buffer_store_dwordx2 v[24:25], v70, s[16:19], s48 offen sc1
  s_mov_b64 exec, -1
  v_mfma_f32_32x32x16_bf16 v[152:167], v[92:95], v[76:79], v[152:167]
  s_add_u32 m0, s57, 114688
  s_nop 0
  buffer_load_dwordx4 v15, s[12:15], s53 offen lds
  s_waitcnt lgkmcnt(0)
  s_cbranch_vccz k1_kernel_sk6
  v_mfma_f32_16x16x32_bf16 v[52:55], v[60:63], v[96:99], v[52:55]
k1_kernel_sk6:
  ds_read_b64_tr_b16 v[88:89], v21 offset:24576
  ds_read_b64_tr_b16 v[90:91], v21 offset:25600
  ds_read_b128 v[72:75], v18 offset:16384
  v_mfma_f32_32x32x16_bf16 v[104:119], v[96:99], v[80:83], v[104:119]
  ds_read_b64_tr_b16 v[92:93], v22 offset:24576
  ds_read_b64_tr_b16 v[94:95], v22 offset:25600
  ds_read_b128 v[76:79], v18 offset:20480
  v_mfma_f32_32x32x16_bf16 v[136:151], v[100:103], v[80:83], v[136:151]
  s_add_u32 m0, s57, 66560
  s_add_u32 s53, s53, s56
  buffer_load_dwordx4 v14, s[8:11], s54 offen lds
  v_mfma_f32_32x32x16_bf16 v[120:135], v[96:99], v[84:87], v[120:135]
  v_mfma_f32_32x32x16_bf16 v[152:167], v[100:103], v[84:87], v[152:167]
  s_add_u32 m0, s57, 115712
  s_nop 0
  buffer_load_dwordx4 v15, s[12:15], s54 offen lds
  s_cmp_ge_u32 s53, s10
  s_cselect_b32 s53, 0, s53
  s_waitcnt lgkmcnt(0)
  s_cbranch_vccz k1_kernel_sk7
  v_mfma_f32_16x16x32_bf16 v[52:55], v[60:63], v[88:91], v[52:55]
k1_kernel_sk7:
  ds_read_b64_tr_b16 v[96:97], v21 offset:28672
  ds_read_b64_tr_b16 v[98:99], v21 offset:29696
  ds_read_b128 v[80:83], v19 offset:16384
  v_mfma_f32_32x32x16_bf16 v[104:119], v[88:91], v[72:75], v[104:119]
  ds_read_b64_tr_b16 v[100:101], v22 offset:28672
  ds_read_b64_tr_b16 v[102:103], v22 offset:29696
  ds_read_b128 v[84:87], v19 offset:20480
  v_mfma_f32_32x32x16_bf16 v[136:151], v[92:95], v[72:75], v[136:151]
  s_add_u32 m0, s57, 0
  s_and_b32 s52, s52, 1023
  buffer_load_dwordx4 v12, s[4:7], s52 offen lds
  v_mfma_f32_32x32x16_bf16 v[120:135], v[88:91], v[76:79], v[120:135]
  v_mfma_f32_32x32x16_bf16 v[152:167], v[92:95], v[76:79], v[152:167]
  s_add_u32 m0, s57, 1024
  s_nop 0
  buffer_load_dwordx4 v13, s[4:7], s52 offen lds
  s_add_u32 s52, s52, 128
  s_waitcnt lgkmcnt(0)
  s_cbranch_vccz k1_kernel_sk8
  v_mfma_f32_16x16x32_bf16 v[52:55], v[60:63], v[96:99], v[52:55]
k1_kernel_sk8:
  v_mfma_f32_32x32x16_bf16 v[104:119], v[96:99], v[80:83], v[104:119]
  v_mfma_f32_32x32x16_bf16 v[136:151], v[100:103], v[80:83], v[136:151]
  s_barrier
  ds_read_b64_tr_b16 v[88:89], v21 offset:32768
  ds_read_b64_tr_b16 v[90:91], v21 offset:33792
  ds_read_b128 v[72:75], v16 offset:32768
  ds_read_b64_tr_b16 v[92:93], v22 offset:32768
  ds_read_b64_tr_b16 v[94:95], v22 offset:33792
  ds_read_b128 v[76:79], v16 offset:36864
  v_mfma_f32_32x32x16_bf16 v[120:135], v[96:99], v[84:87], v[120:135]
  v_mfma_f32_32x32x16_bf16 v[152:167], v[100:103], v[84:87], v[152:167]
  s_waitcnt lgkmcnt(0)
  s_cbranch_vccz k1_kernel_sk9
  v_mfma_f32_16x16x32_bf16 v[52:55], v[60:63], v[88:91], v[52:55]
k1_kernel_sk9:
  ds_read_b64_tr_b16 v[96:97], v21 offset:36864
  ds_read_b64_tr_b16 v[98:99], v21 offset:37888
  ds_read_b128 v[80:83], v17 offset:32768
  v_mfma_f32_32x32x16_bf16 v[104:119], v[88:91], v[72:75], v[104:119]
  ds_read_b64_tr_b16 v[100:101], v22 offset:36864
  ds_read_b64_tr_b16 v[102:103], v22 offset:37888
  ds_read_b128 v[84:87], v17 offset:36864
  v_mfma_f32_32x32x16_bf16 v[136:151], v[92:95], v[72:75], v[136:151]
  v_lshrrev_b32 v8, 3, v1
  s_add_u32 m0, s57, 81920
  s_add_u32 s54, s53, s55
  buffer_load_dwordx4 v14, s[8:11], s53 offen lds
  v_and_b32 v9, 7, v1
  v_mfma_f32_32x32x16_bf16 v[120:135], v[88:91], v[76:79], v[120:135]
  s_and_b32 s48, s2, 3
  s_lshl_b32 s48, s48, 3
  s_add_u32 m0, s57, 131072
  s_nop 0
  buffer_load_dwordx4 v15, s[12:15], s53 offen lds
  v_mfma_f32_32x32x16_bf16 v[152:167], v[92:95], v[76:79], v[152:167]
  s_add_u32 s48, s48, s42
  s_lshl_b32 s48, s48, 3
  v_add_u32 v9, s48, v9
  s_waitcnt lgkmcnt(0)
  s_cbranch_vccz k1_kernel_sk10
  v_mfma_f32_16x16x32_bf16 v[52:55], v[60:63], v[96:99], v[52:55]
k1_kernel_sk10:
  ds_read_b64_tr_b16 v[88:89], v21 offset:40960
  ds_read_b64_tr_b16 v[90:91], v21 offset:41984
  ds_read_b128 v[72:75], v18 offset:32768
  v_mfma_f32_32x32x16_bf16 v[104:119], v[96:99], v[80:83], v[104:119]
  ds_read_b64_tr_b16 v[92:93], v22 offset:40960
  ds_read_b64_tr_b16 v[94:95], v22 offset:41984
  ds_read_b128 v[76:79], v18 offset:36864
  v_mfma_f32_32x32x16_bf16 v[136:151], v[100:103], v[80:83], v[136:151]
  s_lshr_b32 s49, s2, 2
  s_add_u32 m0, s57, 82944
  s_add_u32 s53, s53, s56
  buffer_load_dwordx4 v14, s[8:11], s54 offen lds
  s_and_b32 s49, s49, 3
  v_mfma_f32_32x32x16_bf16 v[120:135], v[96:99], v[84:87], v[120:135]
  s_lshr_b32 s50, s2, 4
  v_lshrrev_b32 v10, 2, v8
  s_add_u32 m0, s57, 132096
  s_nop 0
  buffer_load_dwordx4 v15, s[12:15], s54 offen lds
  s_cmp_ge_u32 s53, s10
  s_cselect_b32 s53, 0, s53
  v_mfma_f32_32x32x16_bf16 v[152:167], v[100:103], v[84:87], v[152:167]
  v_lshlrev_b32 v10, 4, v10
  v_and_b32 v11, 3, v8
  v_add_u32 v10, v10, v11
  s_waitcnt lgkmcnt(0)
  s_cbranch_vccz k1_kernel_sk11
  v_mfma_f32_16x16x32_bf16 v[52:55], v[60:63], v[88:91], v[52:55]
k1_kernel_sk11:
  ds_read_b64_tr_b16 v[96:97], v21 offset:45056
  ds_read_b64_tr_b16 v[98:99], v21 offset:46080
  ds_read_b128 v[80:83], v19 offset:32768
  v_mfma_f32_32x32x16_bf16 v[104:119], v[88:91], v[72:75], v[104:119]
  ds_read_b64_tr_b16 v[100:101], v22 offset:45056
  ds_read_b64_tr_b16 v[102:103], v22 offset:46080
  ds_read_b128 v[84:87], v19 offset:36864
  v_mfma_f32_32x32x16_bf16 v[136:151], v[92:95], v[72:75], v[136:151]
  s_lshl_b32 s51, s49, 2
  s_add_u32 m0, s57, 16384
  s_and_b32 s52, s52, 1023
  buffer_load_dwordx4 v12, s[4:7], s52 offen lds
  v_add_u32 v10, s51, v10
  v_mfma_f32_32x32x16_bf16 v[120:135], v[88:91], v[76:79], v[120:135]
  s_lshl_b32 s51, s50, 7
  v_add_u32 v10, s51, v10
  s_add_u32 m0, s57, 17408
  s_nop 0
  buffer_load_dwordx4 v13, s[4:7], s52 offen lds
  s_add_u32 s52, s52, 128
  v_mfma_f32_32x32x16_bf16 v[152:167], v[92:95], v[76:79], v[152:167]
  v_mul_u32_u24 v10, 514, v10
  v_lshl_add_u32 v28, v9, 1, v10
  v_add_u32 v30, 512, v10
  s_waitcnt lgkmcnt(0)
  s_cbranch_vccz k1_kernel_sk12
  v_mfma_f32_16x16x32_bf16 v[52:55], v[60:63], v[96:99], v[52:55]
k1_kernel_sk12:
  s_lshl_b32 s51, s50, 9
  s_lshl_b32 s49, s49, 7
  s_add_u32 s51, s51, s49
  v_mfma_f32_32x32x16_bf16 v[104:119], v[96:99], v[80:83], v[104:119]
  s_add_u32 s51, s51, 10485760
  v_lshl_add_u32 v8, v8, 4, s51
  v_mfma_f32_32x32x16_bf16 v[136:151], v[100:103], v[80:83], v[136:151]
  v_lshl_add_u32 v29, v9, 13, v8
  v_add_u32 v31, 2097152, v8
  s_waitcnt vmcnt(8)
  s_barrier
  ds_read_b64_tr_b16 v[88:89], v21 offset:0
  ds_read_b64_tr_b16 v[90:91], v21 offset:1024
  ds_read_b128 v[72:75], v16 offset:49152
  ds_read_b64_tr_b16 v[92:93], v22 offset:0
  ds_read_b64_tr_b16 v[94:95], v22 offset:1024
  ds_read_b128 v[76:79], v16 offset:53248
  v_mfma_f32_32x32x16_bf16 v[120:135], v[96:99], v[84:87], v[120:135]
  v_mfma_f32_32x32x16_bf16 v[152:167], v[100:103], v[84:87], v[152:167]
  s_waitcnt lgkmcnt(0)
  s_cbranch_vccz k1_kernel_sk13
  v_mfma_f32_16x16x32_bf16 v[52:55], v[60:63], v[88:91], v[52:55]
k1_kernel_sk13:
  ds_read_b64_tr_b16 v[96:97], v21 offset:4096
  ds_read_b64_tr_b16 v[98:99], v21 offset:5120
  ds_read_b128 v[80:83], v17 offset:49152
  v_mfma_f32_32x32x16_bf16 v[104:119], v[88:91], v[72:75], v[104:119]
  ds_read_b64_tr_b16 v[100:101], v22 offset:4096
  ds_read_b64_tr_b16 v[102:103], v22 offset:5120
  ds_read_b128 v[84:87], v17 offset:53248
  v_mfma_f32_32x32x16_bf16 v[136:151], v[92:95], v[72:75], v[136:151]
  s_add_u32 m0, s57, 98304
  s_add_u32 s54, s53, s55
  buffer_load_dwordx4 v14, s[8:11], s53 offen lds
  v_mfma_f32_32x32x16_bf16 v[120:135], v[88:91], v[76:79], v[120:135]
  v_mfma_f32_32x32x16_bf16 v[152:167], v[92:95], v[76:79], v[152:167]
  s_add_u32 m0, s57, 147456
  s_nop 0
  buffer_load_dwordx4 v15, s[12:15], s53 offen lds
  s_waitcnt lgkmcnt(0)
  s_cbranch_vccz k1_kernel_sk14
  v_mfma_f32_16x16x32_bf16 v[52:55], v[60:63], v[96:99], v[52:55]
k1_kernel_sk14:
  ds_read_b64_tr_b16 v[88:89], v21 offset:8192
  ds_read_b64_tr_b16 v[90:91], v21 offset:9216
  ds_read_b128 v[72:75], v18 offset:49152
  v_mfma_f32_32x32x16_bf16 v[104:119], v[96:99], v[80:83], v[104:119]
  ds_read_b64_tr_b16 v[92:93], v22 offset:8192
  ds_read_b64_tr_b16 v[94:95], v22 offset:9216
  ds_read_b128 v[76:79], v18 offset:53248
  v_mfma_f32_32x32x16_bf16 v[136:151], v[100:103], v[80:83], v[136:151]
  s_add_u32 m0, s57, 99328
  s_add_u32 s53, s53, s56
  buffer_load_dwordx4 v14, s[8:11], s54 offen lds
  v_mfma_f32_32x32x16_bf16 v[120:135], v[96:99], v[84:87], v[120:135]
  v_mfma_f32_32x32x16_bf16 v[152:167], v[100:103], v[84:87], v[152:167]
  s_add_u32 m0, s57, 148480
  s_nop 0
  buffer_load_dwordx4 v15, s[12:15], s54 offen lds
  s_cmp_ge_u32 s53, s10
  s_cselect_b32 s53, 0, s53
  s_waitcnt lgkmcnt(0)
  s_cbranch_vccz k1_kernel_sk15
  v_mfma_f32_16x16x32_bf16 v[52:55], v[60:63], v[88:91], v[52:55]
k1_kernel_sk15:
  ds_read_b64_tr_b16 v[96:97], v21 offset:12288
  ds_read_b64_tr_b16 v[98:99], v21 offset:13312
  ds_read_b128 v[80:83], v19 offset:49152
  v_mfma_f32_32x32x16_bf16 v[104:119], v[88:91], v[72:75], v[104:119]
  ds_read_b64_tr_b16 v[100:101], v22 offset:12288
  ds_read_b64_tr_b16 v[102:103], v22 offset:13312
  ds_read_b128 v[84:87], v19 offset:53248
  v_mfma_f32_32x32x16_bf16 v[136:151], v[92:95], v[72:75], v[136:151]
  s_add_u32 m0, s57, 32768
  s_and_b32 s52, s52, 1023
  buffer_load_dwordx4 v12, s[4:7], s52 offen lds
  v_mfma_f32_32x32x16_bf16 v[120:135], v[88:91], v[76:79], v[120:135]
  v_mfma_f32_32x32x16_bf16 v[152:167], v[92:95], v[76:79], v[152:167]
  s_add_u32 m0, s57, 33792
  s_nop 0
  buffer_load_dwordx4 v13, s[4:7], s52 offen lds
  s_add_u32 s52, s52, 128
  s_waitcnt lgkmcnt(0)
  s_cbranch_vccz k1_kernel_sk16
  v_mfma_f32_16x16x32_bf16 v[52:55], v[60:63], v[96:99], v[52:55]
k1_kernel_sk16:
  v_mfma_f32_32x32x16_bf16 v[104:119], v[96:99], v[80:83], v[104:119]
  s_lshl_b32 s48, s2, 3
  s_add_u32 s48, s48, s42
  s_lshl_b32 s48, s48, 10
  v_lshlrev_b32 v11, 4, v1
  buffer_load_dwordx4 v[204:207], v11, s[28:31], s48 offen
  v_mfma_f32_32x32x16_bf16 v[136:151], v[100:103], v[80:83], v[136:151]
  s_waitcnt vmcnt(9)
  s_barrier
  ds_read_b64_tr_b16 v[88:89], v21 offset:16384
  ds_read_b64_tr_b16 v[90:91], v21 offset:17408
  ds_read_b128 v[72:75], v16 offset:0
  ds_read_b64_tr_b16 v[92:93], v22 offset:16384
  ds_read_b64_tr_b16 v[94:95], v22 offset:17408
  ds_read_b128 v[76:79], v16 offset:4096
  v_mfma_f32_32x32x16_bf16 v[120:135], v[96:99], v[84:87], v[120:135]
  v_mfma_f32_32x32x16_bf16 v[152:167], v[100:103], v[84:87], v[152:167]
  s_waitcnt lgkmcnt(0)
  s_cbranch_vccz k1_kernel_sk17
  v_mfma_f32_16x16x32_bf16 v[52:55], v[60:63], v[88:91], v[52:55]
k1_kernel_sk17:
  ds_read_b64_tr_b16 v[96:97], v21 offset:20480
  ds_read_b64_tr_b16 v[98:99], v21 offset:21504
  ds_read_b128 v[80:83], v17 offset:0
  v_mfma_f32_32x32x16_bf16 v[104:119], v[88:91], v[72:75], v[104:119]
  ds_read_b64_tr_b16 v[100:101], v22 offset:20480
  ds_read_b64_tr_b16 v[102:103], v22 offset:21504
  ds_read_b128 v[84:87], v17 offset:4096
  v_mfma_f32_32x32x16_bf16 v[136:151], v[92:95], v[72:75], v[136:151]
  s_add_u32 m0, s57, 65536
  s_add_u32 s54, s53, s55
  buffer_load_dwordx4 v14, s[8:11], s53 offen lds
  s_mov_b32 s48, 0
  buffer_load_ushort v36, v28, s[20:23], s48 offen
  v_mfma_f32_32x32x16_bf16 v[120:135], v[88:91], v[76:79], v[120:135]
  s_mov_b32 s48, 0
  buffer_load_ushort v44, v28, s[24:27], s48 offen
  s_add_u32 m0, s57, 114688
  s_nop 0
  buffer_load_dwordx4 v15, s[12:15], s53 offen lds
  v_mfma_f32_32x32x16_bf16 v[152:167], v[92:95], v[76:79], v[152:167]
  s_waitcnt lgkmcnt(0)
  s_cbranch_vccz k1_kernel_sk18
  v_mfma_f32_16x16x32_bf16 v[52:55], v[60:63], v[96:99], v[52:55]
k1_kernel_sk18:
  ds_read_b64_tr_b16 v[88:89], v21 offset:24576
  ds_read_b64_tr_b16 v[90:91], v21 offset:25600
  ds_read_b128 v[72:75], v18 offset:0
  v_mfma_f32_32x32x16_bf16 v[104:119], v[96:99], v[80:83], v[104:119]
  ds_read_b64_tr_b16 v[92:93], v22 offset:24576
  ds_read_b64_tr_b16 v[94:95], v22 offset:25600
  ds_read_b128 v[76:79], v18 offset:4096
  v_mfma_f32_32x32x16_bf16 v[136:151], v[100:103], v[80:83], v[136:151]
  s_mov_b32 s48, 16448
  buffer_load_ushort v37, v28, s[20:23], s48 offen
  s_add_u32 m0, s57, 66560
  s_add_u32 s53, s53, s56
  buffer_load_dwordx4 v14, s[8:11], s54 offen lds
  s_mov_b32 s48, 16448
  buffer_load_ushort v45, v28, s[24:27], s48 offen
  v_mfma_f32_32x32x16_bf16 v[120:135], v[96:99], v[84:87], v[120:135]
  s_add_u32 m0, s57, 115712
  s_nop 0
  buffer_load_dwordx4 v15, s[12:15], s54 offen lds
  s_cmp_ge_u32 s53, s10
  s_cselect_b32 s53, 0, s53
  v_mfma_f32_32x32x16_bf16 v[152:167], v[100:103], v[84:87], v[152:167]
  s_waitcnt lgkmcnt(0)
  s_cbranch_vccz k1_kernel_sk19
  v_mfma_f32_16x16x32_bf16 v[52:55], v[60:63], v[88:91], v[52:55]
k1_kernel_sk19:
  ds_read_b64_tr_b16 v[96:97], v21 offset:28672
  ds_read_b64_tr_b16 v[98:99], v21 offset:29696
  ds_read_b128 v[80:83], v19 offset:0
  v_mfma_f32_32x32x16_bf16 v[104:119], v[88:91], v[72:75], v[104:119]
  ds_read_b64_tr_b16 v[100:101], v22 offset:28672
  ds_read_b64_tr_b16 v[102:103], v22 offset:29696
  ds_read_b128 v[84:87], v19 offset:4096
  v_mfma_f32_32x32x16_bf16 v[136:151], v[92:95], v[72:75], v[136:151]
  s_mov_b32 s48, 32896
  buffer_load_ushort v38, v28, s[20:23], s48 offen
  s_add_u32 m0, s57, 49152
  s_and_b32 s52, s52, 1023
  buffer_load_dwordx4 v12, s[4:7], s52 offen lds
  s_mov_b32 s48, 32896
  buffer_load_ushort v46, v28, s[24:27], s48 offen
  v_mfma_f32_32x32x16_bf16 v[120:135], v[88:91], v[76:79], v[120:135]
  s_add_u32 m0, s57, 50176
  s_nop 0
  buffer_load_dwordx4 v13, s[4:7], s52 offen lds
  s_add_u32 s52, s52, 128
  v_mfma_f32_32x32x16_bf16 v[152:167], v[92:95], v[76:79], v[152:167]
  s_mov_b32 s48, 49344
  buffer_load_ushort v39, v28, s[20:23], s48 offen
  s_waitcnt lgkmcnt(0)
  s_cbranch_vccz k1_kernel_sk20
  v_mfma_f32_16x16x32_bf16 v[52:55], v[60:63], v[96:99], v[52:55]
k1_kernel_sk20:
  s_mov_b32 s48, 49344
  buffer_load_ushort v47, v28, s[24:27], s48 offen
  s_and_b32 s48, s2, 3
  s_lshl_b32 s48, s48, 3
  s_add_u32 s48, s48, s42
  s_cmp_lg_u32 s48, 31
  s_cbranch_scc1 k1_kernel_c256a
  s_mov_b32 s48, 0
  buffer_load_ushort v40, v30, s[20:23], s48 offen
  buffer_load_ushort v48, v30, s[24:27], s48 offen
  s_mov_b32 s48, 16448
  buffer_load_ushort v41, v30, s[20:23], s48 offen
  buffer_load_ushort v49, v30, s[24:27], s48 offen
  s_mov_b32 s48, 32896
  buffer_load_ushort v42, v30, s[20:23], s48 offen
  buffer_load_ushort v50, v30, s[24:27], s48 offen
  s_mov_b32 s48, 49344
  buffer_load_ushort v43, v30, s[20:23], s48 offen
  buffer_load_ushort v51, v30, s[24:27], s48 offen
k1_kernel_c256a:
  v_mfma_f32_32x32x16_bf16 v[104:119], v[96:99], v[80:83], v[104:119]
  v_mfma_f32_32x32x16_bf16 v[136:151], v[100:103], v[80:83], v[136:151]
  s_waitcnt vmcnt(17)
  s_barrier
  ds_read_b64_tr_b16 v[88:89], v21 offset:32768
  ds_read_b64_tr_b16 v[90:91], v21 offset:33792
  ds_read_b128 v[72:75], v16 offset:16384
  ds_read_b64_tr_b16 v[92:93], v22 offset:32768
  ds_read_b64_tr_b16 v[94:95], v22 offset:33792
  ds_read_b128 v[76:79], v16 offset:20480
  v_mfma_f32_32x32x16_bf16 v[120:135], v[96:99], v[84:87], v[120:135]
  v_mfma_f32_32x32x16_bf16 v[152:167], v[100:103], v[84:87], v[152:167]
  s_waitcnt lgkmcnt(0)
  s_cbranch_vccz k1_kernel_sk21
  v_mfma_f32_16x16x32_bf16 v[52:55], v[60:63], v[88:91], v[52:55]
k1_kernel_sk21:
  ds_read_b64_tr_b16 v[96:97], v21 offset:36864
  ds_read_b64_tr_b16 v[98:99], v21 offset:37888
  ds_read_b128 v[80:83], v17 offset:16384
  v_mfma_f32_32x32x16_bf16 v[104:119], v[88:91], v[72:75], v[104:119]
  ds_read_b64_tr_b16 v[100:101], v22 offset:36864
  ds_read_b64_tr_b16 v[102:103], v22 offset:37888
  ds_read_b128 v[84:87], v17 offset:20480
  v_mfma_f32_32x32x16_bf16 v[136:151], v[92:95], v[72:75], v[136:151]
  s_add_u32 m0, s57, 81920
  s_add_u32 s54, s53, s55
  buffer_load_dwordx4 v14, s[8:11], s53 offen lds
  v_mfma_f32_32x32x16_bf16 v[120:135], v[88:91], v[76:79], v[120:135]
  v_mfma_f32_32x32x16_bf16 v[152:167], v[92:95], v[76:79], v[152:167]
  s_add_u32 m0, s57, 131072
  s_nop 0
  buffer_load_dwordx4 v15, s[12:15], s53 offen lds
  s_waitcnt lgkmcnt(0)
  s_cbranch_vccz k1_kernel_sk22
  v_mfma_f32_16x16x32_bf16 v[52:55], v[60:63], v[96:99], v[52:55]
k1_kernel_sk22:
  ds_read_b64_tr_b16 v[88:89], v21 offset:40960
  ds_read_b64_tr_b16 v[90:91], v21 offset:41984
  ds_read_b128 v[72:75], v18 offset:16384
  v_mfma_f32_32x32x16_bf16 v[104:119], v[96:99], v[80:83], v[104:119]
  ds_read_b64_tr_b16 v[92:93], v22 offset:40960
  ds_read_b64_tr_b16 v[94:95], v22 offset:41984
  ds_read_b128 v[76:79], v18 offset:20480
  v_mfma_f32_32x32x16_bf16 v[136:151], v[100:103], v[80:83], v[136:151]
  s_add_u32 m0, s57, 82944
  s_add_u32 s53, s53, s56
  buffer_load_dwordx4 v14, s[8:11], s54 offen lds
  v_mfma_f32_32x32x16_bf16 v[120:135], v[96:99], v[84:87], v[120:135]
  v_mfma_f32_32x32x16_bf16 v[152:167], v[100:103], v[84:87], v[152:167]
  s_add_u32 m0, s57, 132096
  s_nop 0
  buffer_load_dwordx4 v15, s[12:15], s54 offen lds
  s_cmp_ge_u32 s53, s10
  s_cselect_b32 s53, 0, s53
  s_waitcnt lgkmcnt(0)
  s_cbranch_vccz k1_kernel_sk23
  v_mfma_f32_16x16x32_bf16 v[52:55], v[60:63], v[88:91], v[52:55]
k1_kernel_sk23:
  ds_read_b64_tr_b16 v[96:97], v21 offset:45056
  ds_read_b64_tr_b16 v[98:99], v21 offset:46080
  v_mfma_f32_32x32x16_bf16 v[104:119], v[88:91], v[72:75], v[104:119]
  ds_read_b128 v[80:83], v19 offset:16384
  ds_read_b64_tr_b16 v[100:101], v22 offset:45056
  v_mfma_f32_32x32x16_bf16 v[136:151], v[92:95], v[72:75], v[136:151]
  ds_read_b64_tr_b16 v[102:103], v22 offset:46080
  ds_read_b128 v[84:87], v19 offset:20480
  v_mfma_f32_32x32x16_bf16 v[120:135], v[88:91], v[76:79], v[120:135]
  s_waitcnt vmcnt(18)
  s_cmp_ge_u32 s2, 224
  s_cbranch_scc1 k1_kernel_nowds
  s_lshl_b32 s48, s2, 3
  s_add_u32 s48, s48, s42
  s_lshl_b32 s48, s48, 7
  s_add_u32 s48, s48, 16777216
  v_lshrrev_b32 v11, 3, v1
  v_mul_u32_u24 v11, 229376, v11
  v_and_b32 v10, 7, v1
  v_lshl_add_u32 v11, v10, 4, v11
  buffer_store_dwordx4 v[204:207], v11, s[16:19], s48 offen sc1
k1_kernel_nowds:
  v_mfma_f32_32x32x16_bf16 v[152:167], v[92:95], v[76:79], v[152:167]
  s_waitcnt lgkmcnt(0)
  s_cbranch_vccz k1_kernel_sk24
  v_mfma_f32_16x16x32_bf16 v[52:55], v[60:63], v[96:99], v[52:55]
k1_kernel_sk24:
  s_cmp_ge_u32 s2, 8
  s_cbranch_scc1 k1_kernel_notn
  s_getpc_b64 s[32:33]
  s_add_u32 s32, s32, k23_begin@rel32@lo+4
  s_addc_u32 s33, s33, k23_begin@rel32@hi+12
  s_mov_b32 s34, k23_end-k23_begin
  s_lshl_b32 s48, s42, 13
  s_and_b32 s33, s33, 0xffff
  s_mov_b32 s35, 0x00020000
  v_lshlrev_b32 v11, 7, v1
  buffer_load_dword v33, v11, s[32:35], s48 offen
k1_kernel_notn:
  v_mfma_f32_32x32x16_bf16 v[104:119], v[96:99], v[80:83], v[104:119]
  v_mfma_f32_32x32x16_bf16 v[136:151], v[100:103], v[80:83], v[136:151]
  s_waitcnt vmcnt(10)
  s_barrier
  ds_read_b64_tr_b16 v[88:89], v21 offset:0
  ds_read_b64_tr_b16 v[90:91], v21 offset:1024
  ds_read_b128 v[72:75], v16 offset:32768
  ds_read_b64_tr_b16 v[92:93], v22 offset:0
  ds_read_b64_tr_b16 v[94:95], v22 offset:1024
  ds_read_b128 v[76:79], v16 offset:36864
  v_mfma_f32_32x32x16_bf16 v[120:135], v[96:99], v[84:87], v[120:135]
  v_mfma_f32_32x32x16_bf16 v[152:167], v[100:103], v[84:87], v[152:167]
  s_waitcnt lgkmcnt(0)
  s_cbranch_vccz k1_kernel_sk25
  v_mfma_f32_16x16x32_bf16 v[52:55], v[60:63], v[88:91], v[52:55]
k1_kernel_sk25:
  ds_read_b64_tr_b16 v[96:97], v21 offset:4096
  ds_read_b64_tr_b16 v[98:99], v21 offset:5120
  v_mfma_f32_32x32x16_bf16 v[104:119], v[88:91], v[72:75], v[104:119]
  ds_read_b128 v[80:83], v17 offset:32768
  ds_read_b64_tr_b16 v[100:101], v22 offset:4096
  v_mfma_f32_32x32x16_bf16 v[136:151], v[92:95], v[72:75], v[136:151]
  ds_read_b64_tr_b16 v[102:103], v22 offset:5120
  ds_read_b128 v[84:87], v17 offset:36864
  v_mfma_f32_32x32x16_bf16 v[120:135], v[88:91], v[76:79], v[120:135]
  v_mfma_f32_32x32x16_bf16 v[152:167], v[92:95], v[76:79], v[152:167]
  s_waitcnt lgkmcnt(0)
  s_cbranch_vccz k1_kernel_sk26
  v_mfma_f32_16x16x32_bf16 v[52:55], v[60:63], v[96:99], v[52:55]
k1_kernel_sk26:
  ds_read_b64_tr_b16 v[88:89], v21 offset:8192
  ds_read_b64_tr_b16 v[90:91], v21 offset:9216
  v_mfma_f32_32x32x16_bf16 v[104:119], v[96:99], v[80:83], v[104:119]
  ds_read_b128 v[72:75], v18 offset:32768
  ds_read_b64_tr_b16 v[92:93], v22 offset:8192
  v_mfma_f32_32x32x16_bf16 v[136:151], v[100:103], v[80:83], v[136:151]
  ds_read_b64_tr_b16 v[94:95], v22 offset:9216
  ds_read_b128 v[76:79], v18 offset:36864
  v_mfma_f32_32x32x16_bf16 v[120:135], v[96:99], v[84:87], v[120:135]
  s_lshl_b32 s52, s40, 10
  s_lshl_b32 s49, s44, 9
  s_add_u32 s52, s52, s49
  s_add_u32 s52, s52, 15728640
  v_lshlrev_b32 v71, 3, v2
  buffer_load_dwordx2 v[24:25], v71, s[16:19], s52 offen offset:0 sc1
  buffer_load_dwordx2 v[26:27], v71, s[16:19], s52 offen offset:256 sc1
  v_mfma_f32_32x32x16_bf16 v[152:167], v[100:103], v[84:87], v[152:167]
  s_waitcnt lgkmcnt(0)
  s_cbranch_vccz k1_kernel_sk27
  v_mfma_f32_16x16x32_bf16 v[52:55], v[60:63], v[88:91], v[52:55]
k1_kernel_sk27:
  ds_read_b64_tr_b16 v[96:97], v21 offset:12288
  ds_read_b64_tr_b16 v[98:99], v21 offset:13312
  ds_read_b128 v[80:83], v19 offset:32768
  v_mfma_f32_32x32x16_bf16 v[104:119], v[88:91], v[72:75], v[104:119]
  ds_read_b64_tr_b16 v[100:101], v22 offset:12288
  ds_read_b64_tr_b16 v[102:103], v22 offset:13312
  ds_read_b128 v[84:87], v19 offset:36864
  v_mfma_f32_32x32x16_bf16 v[136:151], v[92:95], v[72:75], v[136:151]
  s_lshl_b32 s50, s58, 9
  s_waitcnt vmcnt(6)
  v_lshl_or_b32 v36, v44, 16, v36
  v_lshl_or_b32 v37, v45, 16, v37
  v_lshl_or_b32 v38, v46, 16, v38
  v_lshl_or_b32 v39, v47, 16, v39
  buffer_store_dwordx4 v[36:39], v29, s[16:19], 0 offen sc1
  s_and_b32 s48, s2, 3
  s_lshl_b32 s48, s48, 3
  s_add_u32 s48, s48, s42
  s_cmp_lg_u32 s48, 31
  s_cbranch_scc1 k1_kernel_c256b
  v_lshl_or_b32 v40, v48, 16, v40
  v_lshl_or_b32 v41, v49, 16, v41
  v_lshl_or_b32 v42, v50, 16, v42
  v_lshl_or_b32 v43, v51, 16, v43
  buffer_store_dwordx4 v[40:43], v31, s[16:19], 0 offen sc1
k1_kernel_c256b:
  s_add_u32 s50, s50, 106496
  v_mfma_f32_32x32x16_bf16 v[120:135], v[88:91], v[76:79], v[120:135]
  v_lshlrev_b32 v9, 3, v1
  v_mfma_f32_32x32x16_bf16 v[152:167], v[92:95], v[76:79], v[152:167]
  v_add_u32 v9, s50, v9
  s_waitcnt lgkmcnt(0)
  s_cbranch_vccz k1_kernel_sk28
  v_mfma_f32_16x16x32_bf16 v[52:55], v[60:63], v[96:99], v[52:55]
k1_kernel_sk28:
  v_mfma_f32_32x32x16_bf16 v[104:119], v[96:99], v[80:83], v[104:119]
  v_mfma_f32_32x32x16_bf16 v[136:151], v[100:103], v[80:83], v[136:151]
  s_nop 5
  ds_write_b64 v9, v[52:53]
  s_waitcnt lgkmcnt(0)
  s_waitcnt vmcnt(3)
  s_barrier
  ds_read_b64_tr_b16 v[88:89], v21 offset:16384
  ds_read_b64_tr_b16 v[90:91], v21 offset:17408
  ds_read_b128 v[72:75], v16 offset:49152
  ds_read_b64_tr_b16 v[92:93], v22 offset:16384
  ds_read_b64_tr_b16 v[94:95], v22 offset:17408
  ds_read_b128 v[76:79], v16 offset:53248
  v_mfma_f32_32x32x16_bf16 v[120:135], v[96:99], v[84:87], v[120:135]
  v_xor_b32 v9, 512, v9
  ds_read_b64 v[188:189], v9
  v_mfma_f32_32x32x16_bf16 v[152:167], v[100:103], v[84:87], v[152:167]
  s_waitcnt lgkmcnt(0)
  v_mfma_f32_16x16x32_bf16 v[52:55], v[60:63], v[88:91], v[52:55]
  ds_read_b64_tr_b16 v[96:97], v21 offset:20480
  ds_read_b64_tr_b16 v[98:99], v21 offset:21504
  ds_read_b128 v[80:83], v17 offset:49152
  ds_read_b64_tr_b16 v[100:101], v22 offset:20480
  v_mfma_f32_16x16x32_bf16 v[56:59], v[60:63], v[92:95], 0
  ds_read_b64_tr_b16 v[102:103], v22 offset:21504
  ds_read_b128 v[84:87], v17 offset:53248
  s_waitcnt vmcnt(1)
  s_mov_b32 s51, 16384
k1_kernel_sp:
  v_xor_b32 v68, s64, v25
  v_xor_b32 v69, s64, v27
  v_or_b32 v68, v68, v69
  v_cmp_ne_u32 vcc, 0, v68
  s_nop 3
  s_cbranch_vccz k1_kernel_spok
  s_sub_u32 s51, s51, 1
  s_cbranch_scc1 k1_kernel_spok
  s_sleep 8
  buffer_load_dwordx2 v[24:25], v71, s[16:19], s52 offen offset:0 sc1
  buffer_load_dwordx2 v[26:27], v71, s[16:19], s52 offen offset:256 sc1
  s_waitcnt vmcnt(0)
  s_branch k1_kernel_sp
k1_kernel_spok:
  v_cmp_eq_u32 vcc, 0, v3
  v_mfma_f32_32x32x16_bf16 v[104:119], v[88:91], v[72:75], v[104:119]
  v_mov_b32 v194, 0
  v_mov_b32 v195, 0
  v_mov_b32 v198, 0
  v_mfma_f32_32x32x16_bf16 v[136:151], v[92:95], v[72:75], v[136:151]
  v_mov_b32 v199, 0
  v_mov_b32 v186, 0
  v_mov_b32 v187, 0
  v_mfma_f32_32x32x16_bf16 v[120:135], v[88:91], v[76:79], v[120:135]
  v_mov_b32 v190, 0
  v_mov_b32 v191, 0
  v_bfe_u32 v4, v1, 4, 1
  v_mfma_f32_32x32x16_bf16 v[152:167], v[92:95], v[76:79], v[152:167]
  v_and_b32 v25, 0xffff0000, v24
  v_and_b32 v27, 0xffff0000, v26
  v_rcp_f32 v25, v25
  s_waitcnt lgkmcnt(0)
  v_mfma_f32_16x16x32_bf16 v[52:55], v[60:63], v[96:99], v[52:55]
  ds_read_b64_tr_b16 v[88:89], v21 offset:24576
  ds_read_b64_tr_b16 v[90:91], v21 offset:25600
  ds_read_b128 v[72:75], v18 offset:49152
  ds_read_b64_tr_b16 v[92:93], v22 offset:24576
  v_mfma_f32_16x16x32_bf16 v[56:59], v[60:63], v[100:103], v[56:59]
  ds_read_b64_tr_b16 v[94:95], v22 offset:25600
  ds_read_b128 v[76:79], v18 offset:53248
  v_rcp_f32 v27, v27
  v_and_b32 v24, 0xffff, v24
  v_mfma_f32_32x32x16_bf16 v[104:119], v[96:99], v[80:83], v[104:119]
  v_and_b32 v26, 0xffff, v26
  v_lshl_or_b32 v24, v24, 16, v24
  v_lshl_or_b32 v26, v26, 16, v26
  v_mfma_f32_32x32x16_bf16 v[136:151], v[100:103], v[80:83], v[136:151]
  v_cndmask_b32 v192, 0, v24, vcc
  v_cndmask_b32 v196, 0, v26, vcc
  v_cmp_eq_u32 vcc, 1, v4
  v_mfma_f32_32x32x16_bf16 v[120:135], v[96:99], v[84:87], v[120:135]
  v_mov_b32 v193, v192
  v_mov_b32 v197, v196
  v_cndmask_b32 v200, v188, v189, vcc
  v_mfma_f32_32x32x16_bf16 v[152:167], v[100:103], v[84:87], v[152:167]
  s_cmp_ge_u32 s41, 14
  s_cselect_b64 s[76:77], -1, 0
  s_xor_b32 s48, s58, 0
  s_sub_u32 s49, s41, 14
  s_waitcnt lgkmcnt(0)
  v_mfma_f32_16x16x32_bf16 v[52:55], v[60:63], v[88:91], v[52:55]
  ds_read_b64_tr_b16 v[96:97], v21 offset:28672
  ds_read_b64_tr_b16 v[98:99], v21 offset:29696
  ds_read_b128 v[80:83], v19 offset:49152
  ds_read_b64_tr_b16 v[100:101], v22 offset:28672
  v_mfma_f32_16x16x32_bf16 v[56:59], v[60:63], v[92:95], v[56:59]
  ds_read_b64_tr_b16 v[102:103], v22 offset:29696
  ds_read_b128 v[84:87], v19 offset:53248
  s_or_b32 s48, s48, s49
  v_or_b32 v64, s48, v2
  v_mfma_f32_32x32x16_bf16 v[104:119], v[88:91], v[72:75], v[104:119]
  v_min_u32 v64, 1, v64
  v_sub_u32 v64, 1, v64
  v_mul_u32_u24 v64, 0x4380, v64
  v_mfma_f32_32x32x16_bf16 v[136:151], v[92:95], v[72:75], v[136:151]
  v_lshlrev_b32 v64, 16, v64
  s_xor_b32 s48, s58, 1
  s_sub_u32 s49, s41, 14
  v_mfma_f32_32x32x16_bf16 v[120:135], v[88:91], v[76:79], v[120:135]
  s_or_b32 s48, s48, s49
  v_or_b32 v65, s48, v2
  v_min_u32 v65, 1, v65
  v_mfma_f32_32x32x16_bf16 v[152:167], v[92:95], v[76:79], v[152:167]
  v_sub_u32 v65, 1, v65
  v_mul_u32_u24 v65, 0x4380, v65
  v_lshlrev_b32 v65, 16, v65
  s_waitcnt lgkmcnt(0)
  v_mfma_f32_16x16x32_bf16 v[52:55], v[60:63], v[96:99], v[52:55]
  v_mfma_f32_16x16x32_bf16 v[56:59], v[60:63], v[100:103], v[56:59]
  v_mfma_f32_32x32x16_bf16 v[104:119], v[96:99], v[80:83], v[104:119]
  v_mfma_f32_32x32x16_bf16 v[136:151], v[100:103], v[80:83], v[136:151]
  s_nop 3
  v_mfma_f32_32x32x16_bf16 v[120:135], v[96:99], v[84:87], v[120:135]
  v_cndmask_b32 v4, v52, v53, vcc
  v_cndmask_b32 v7, v56, v57, vcc
  v_add_f32 v7, v7, v200
  v_cndmask_b32 v4, v4, v64, s[76:77]
  v_cndmask_b32 v7, v7, v65, s[76:77]
  v_and_b32 v6, 0xffff0000, v4
  v_and_b32 v9, 0xffff0000, v7
  v_sub_f32 v5, v4, v6
  v_sub_f32 v8, v7, v9
  v_and_b32 v4, 0xffff0000, v5
  v_mfma_f32_32x32x16_bf16 v[152:167], v[100:103], v[84:87], v[152:167]
  v_and_b32 v7, 0xffff0000, v8
  v_sub_f32 v5, v5, v4
  v_sub_f32 v8, v8, v7
  v_lshrrev_b32 v6, 16, v6
  v_lshrrev_b32 v9, 16, v9
  v_or_b32 v184, v6, v4
  v_or_b32 v188, v9, v7
  v_lshrrev_b32 v185, 16, v5
  v_lshrrev_b32 v189, 16, v8
  s_nop 1
  v_mfma_f32_32x32x16_bf16 v[104:119], v[184:187], v[192:195], v[104:119]
  v_mfma_f32_32x32x16_bf16 v[136:151], v[188:191], v[192:195], v[136:151]
  v_mfma_f32_32x32x16_bf16 v[120:135], v[184:187], v[196:199], v[120:135]
  v_mfma_f32_32x32x16_bf16 v[152:167], v[188:191], v[196:199], v[152:167]
  s_cmp_ge_u32 s41, 14
  s_cbranch_scc1 k1_kernel_epi_dft
  v_mul_f32 v172, v25, v25
  v_mul_f32 v174, v27, v27
  v_lshlrev_b32 v4, 4, v1
  s_lshl_b32 s48, s40, 2
  s_lshl_b32 s50, s44, 1
  s_add_u32 s48, s48, s50
  s_mul_i32 s48, s48, 112
  s_lshl_b32 s50, s41, 3
  s_add_u32 s48, s48, s50
  v_max_f32 v104, 0, v104
  v_mul_f32 v112, v172, v112
  v_max_f32 v105, 0, v105
  v_mul_f32 v113, v172, v113
  v_max_f32 v106, 0, v106
  v_mul_f32 v114, v172, v114
  v_max_f32 v107, 0, v107
  v_mul_f32 v115, v172, v115
  v_max_f32 v108, 0, v108
  v_mul_f32 v116, v172, v116
  v_max_f32 v109, 0, v109
  v_mul_f32 v117, v172, v117
  v_max_f32 v110, 0, v110
  v_mul_f32 v118, v172, v118
  v_max_f32 v111, 0, v111
  v_mul_f32 v119, v172, v119
  v_mul_f32 v104, v104, v112
  v_mul_f32 v105, v105, v113
  v_mul_f32 v106, v106, v114
  v_mul_f32 v107, v107, v115
  v_mul_f32 v108, v108, v116
  v_mul_f32 v109, v109, v117
  v_mul_f32 v110, v110, v118
  v_mul_f32 v111, v111, v119
  v_cvt_pk_bf16_f32 v112, v104, v105
  v_cvt_pk_bf16_f32 v113, v106, v107
  v_cvt_pk_bf16_f32 v114, v108, v109
  v_cvt_pk_bf16_f32 v115, v110, v111
  s_xor_b32 s50, s58, 0
  s_add_u32 s50, s50, s48
  s_lshl_b32 s50, s50, 10
  buffer_store_dwordx4 v[112:115], v4, s[16:19], s50 offen sc1
  v_max_f32 v136, 0, v136
  v_mul_f32 v144, v172, v144
  v_max_f32 v137, 0, v137
  v_mul_f32 v145, v172, v145
  v_max_f32 v138, 0, v138
  v_mul_f32 v146, v172, v146
  v_max_f32 v139, 0, v139
  v_mul_f32 v147, v172, v147
  v_max_f32 v140, 0, v140
  v_mul_f32 v148, v172, v148
  v_max_f32 v141, 0, v141
  v_mul_f32 v149, v172, v149
  v_max_f32 v142, 0, v142
  v_mul_f32 v150, v172, v150
  v_max_f32 v143, 0, v143
  v_mul_f32 v151, v172, v151
  v_mul_f32 v136, v136, v144
  v_mul_f32 v137, v137, v145
  v_mul_f32 v138, v138, v146
  v_mul_f32 v139, v139, v147
  v_mul_f32 v140, v140, v148
  v_mul_f32 v141, v141, v149
  v_mul_f32 v142, v142, v150
  v_mul_f32 v143, v143, v151
  v_cvt_pk_bf16_f32 v144, v136, v137
  v_cvt_pk_bf16_f32 v145, v138, v139
  v_cvt_pk_bf16_f32 v146, v140, v141
  v_cvt_pk_bf16_f32 v147, v142, v143
  s_xor_b32 s50, s58, 1
  s_add_u32 s50, s50, s48
  s_lshl_b32 s50, s50, 10
  buffer_store_dwordx4 v[144:147], v4, s[16:19], s50 offen sc1
  v_max_f32 v120, 0, v120
  v_mul_f32 v128, v174, v128
  v_max_f32 v121, 0, v121
  v_mul_f32 v129, v174, v129
  v_max_f32 v122, 0, v122
  v_mul_f32 v130, v174, v130
  v_max_f32 v123, 0, v123
  v_mul_f32 v131, v174, v131
  v_max_f32 v124, 0, v124
  v_mul_f32 v132, v174, v132
  v_max_f32 v125, 0, v125
  v_mul_f32 v133, v174, v133
  v_max_f32 v126, 0, v126
  v_mul_f32 v134, v174, v134
  v_max_f32 v127, 0, v127
  v_mul_f32 v135, v174, v135
  v_mul_f32 v120, v120, v128
  v_mul_f32 v121, v121, v129
  v_mul_f32 v122, v122, v130
  v_mul_f32 v123, v123, v131
  v_mul_f32 v124, v124, v132
  v_mul_f32 v125, v125, v133
  v_mul_f32 v126, v126, v134
  v_mul_f32 v127, v127, v135
  v_cvt_pk_bf16_f32 v128, v120, v121
  v_cvt_pk_bf16_f32 v129, v122, v123
  v_cvt_pk_bf16_f32 v130, v124, v125
  v_cvt_pk_bf16_f32 v131, v126, v127
  s_xor_b32 s50, s58, 0
  s_add_u32 s50, s50, s48
  s_add_u32 s50, s50, 112
  s_lshl_b32 s50, s50, 10
  buffer_store_dwordx4 v[128:131], v4, s[16:19], s50 offen sc1
  v_max_f32 v152, 0, v152
  v_mul_f32 v160, v174, v160
  v_max_f32 v153, 0, v153
  v_mul_f32 v161, v174, v161
  v_max_f32 v154, 0, v154
  v_mul_f32 v162, v174, v162
  v_max_f32 v155, 0, v155
  v_mul_f32 v163, v174, v163
  v_max_f32 v156, 0, v156
  v_mul_f32 v164, v174, v164
  v_max_f32 v157, 0, v157
  v_mul_f32 v165, v174, v165
  v_max_f32 v158, 0, v158
  v_mul_f32 v166, v174, v166
  v_max_f32 v159, 0, v159
  v_mul_f32 v167, v174, v167
  v_mul_f32 v152, v152, v160
  v_mul_f32 v153, v153, v161
  v_mul_f32 v154, v154, v162
  v_mul_f32 v155, v155, v163
  v_mul_f32 v156, v156, v164
  v_mul_f32 v157, v157, v165
  v_mul_f32 v158, v158, v166
  v_mul_f32 v159, v159, v167
  v_cvt_pk_bf16_f32 v160, v152, v153
  v_cvt_pk_bf16_f32 v161, v154, v155
  v_cvt_pk_bf16_f32 v162, v156, v157
  v_cvt_pk_bf16_f32 v163, v158, v159
  s_xor_b32 s50, s58, 1
  s_add_u32 s50, s50, s48
  s_add_u32 s50, s50, 112
  s_lshl_b32 s50, s50, 10
  buffer_store_dwordx4 v[160:163], v4, s[16:19], s50 offen sc1
  s_endpgm
k1_kernel_epi_dft:
  v_mul_f32 v25, 0x36000000, v25
  v_mul_f32 v27, 0x36000000, v27
  v_lshlrev_b32 v4, 14, v3
  v_lshl_add_u32 v4, v2, 2, v4
  s_sub_u32 s48, s41, 14
  s_lshl_b32 s48, s48, 20
  s_add_u32 s48, s48, 8388608
  s_lshl_b32 s50, s40, 9
  s_add_u32 s48, s48, s50
  s_lshl_b32 s50, s44, 8
  s_add_u32 s48, s48, s50
  s_xor_b32 s50, s58, 0
  s_lshl_b32 s50, s50, 16
  s_add_u32 s50, s50, s48
  v_mul_f32 v104, v25, v104
  v_mul_f32 v105, v25, v105
  v_mul_f32 v106, v25, v106
  v_mul_f32 v107, v25, v107
  v_mul_f32 v108, v25, v108
  v_mul_f32 v109, v25, v109
  v_mul_f32 v110, v25, v110
  v_mul_f32 v111, v25, v111
  v_mul_f32 v112, v25, v112
  v_mul_f32 v113, v25, v113
  v_mul_f32 v114, v25, v114
  v_mul_f32 v115, v25, v115
  v_mul_f32 v116, v25, v116
  v_mul_f32 v117, v25, v117
  v_mul_f32 v118, v25, v118
  v_mul_f32 v119, v25, v119
  v_cvt_pk_bf16_f32 v104, v104, v105
  v_cvt_pk_bf16_f32 v106, v106, v107
  v_cvt_pk_bf16_f32 v108, v108, v109
  v_cvt_pk_bf16_f32 v110, v110, v111
  v_cvt_pk_bf16_f32 v112, v112, v113
  v_cvt_pk_bf16_f32 v114, v114, v115
  v_cvt_pk_bf16_f32 v116, v116, v117
  v_cvt_pk_bf16_f32 v118, v118, v119
  s_add_u32 s51, s50, 0
  buffer_store_dword v104, v4, s[16:19], s51 offen offset:0 sc1
  s_add_u32 s51, s50, 8192
  buffer_store_dword v106, v4, s[16:19], s51 offen offset:0 sc1
  s_add_u32 s51, s50, 32768
  buffer_store_dword v108, v4, s[16:19], s51 offen offset:0 sc1
  s_add_u32 s51, s50, 40960
  buffer_store_dword v110, v4, s[16:19], s51 offen offset:0 sc1
  s_add_u32 s51, s50, 524288
  buffer_store_dword v112, v4, s[16:19], s51 offen offset:0 sc1
  s_add_u32 s51, s50, 532480
  buffer_store_dword v114, v4, s[16:19], s51 offen offset:0 sc1
  s_add_u32 s51, s50, 557056
  buffer_store_dword v116, v4, s[16:19], s51 offen offset:0 sc1
  s_add_u32 s51, s50, 565248
  buffer_store_dword v118, v4, s[16:19], s51 offen offset:0 sc1
  s_xor_b32 s50, s58, 1
  s_lshl_b32 s50, s50, 16
  s_add_u32 s50, s50, s48
  v_mul_f32 v136, v25, v136
  v_mul_f32 v137, v25, v137
  v_mul_f32 v138, v25, v138
  v_mul_f32 v139, v25, v139
  v_mul_f32 v140, v25, v140
  v_mul_f32 v141, v25, v141
  v_mul_f32 v142, v25, v142
  v_mul_f32 v143, v25, v143
  v_mul_f32 v144, v25, v144
  v_mul_f32 v145, v25, v145
  v_mul_f32 v146, v25, v146
  v_mul_f32 v147, v25, v147
  v_mul_f32 v148, v25, v148
  v_mul_f32 v149, v25, v149
  v_mul_f32 v150, v25, v150
  v_mul_f32 v151, v25, v151
  v_cvt_pk_bf16_f32 v136, v136, v137
  v_cvt_pk_bf16_f32 v138, v138, v139
  v_cvt_pk_bf16_f32 v140, v140, v141
  v_cvt_pk_bf16_f32 v142, v142, v143
  v_cvt_pk_bf16_f32 v144, v144, v145
  v_cvt_pk_bf16_f32 v146, v146, v147
  v_cvt_pk_bf16_f32 v148, v148, v149
  v_cvt_pk_bf16_f32 v150, v150, v151
  s_add_u32 s51, s50, 0
  buffer_store_dword v136, v4, s[16:19], s51 offen offset:0 sc1
  s_add_u32 s51, s50, 8192
  buffer_store_dword v138, v4, s[16:19], s51 offen offset:0 sc1
  s_add_u32 s51, s50, 32768
  buffer_store_dword v140, v4, s[16:19], s51 offen offset:0 sc1
  s_add_u32 s51, s50, 40960
  buffer_store_dword v142, v4, s[16:19], s51 offen offset:0 sc1
  s_add_u32 s51, s50, 524288
  buffer_store_dword v144, v4, s[16:19], s51 offen offset:0 sc1
  s_add_u32 s51, s50, 532480
  buffer_store_dword v146, v4, s[16:19], s51 offen offset:0 sc1
  s_add_u32 s51, s50, 557056
  buffer_store_dword v148, v4, s[16:19], s51 offen offset:0 sc1
  s_add_u32 s51, s50, 565248
  buffer_store_dword v150, v4, s[16:19], s51 offen offset:0 sc1
  s_xor_b32 s50, s58, 0
  s_lshl_b32 s50, s50, 16
  s_add_u32 s50, s50, s48
  v_mul_f32 v120, v27, v120
  v_mul_f32 v121, v27, v121
  v_mul_f32 v122, v27, v122
  v_mul_f32 v123, v27, v123
  v_mul_f32 v124, v27, v124
  v_mul_f32 v125, v27, v125
  v_mul_f32 v126, v27, v126
  v_mul_f32 v127, v27, v127
  v_mul_f32 v128, v27, v128
  v_mul_f32 v129, v27, v129
  v_mul_f32 v130, v27, v130
  v_mul_f32 v131, v27, v131
  v_mul_f32 v132, v27, v132
  v_mul_f32 v133, v27, v133
  v_mul_f32 v134, v27, v134
  v_mul_f32 v135, v27, v135
  v_cvt_pk_bf16_f32 v120, v120, v121
  v_cvt_pk_bf16_f32 v122, v122, v123
  v_cvt_pk_bf16_f32 v124, v124, v125
  v_cvt_pk_bf16_f32 v126, v126, v127
  v_cvt_pk_bf16_f32 v128, v128, v129
  v_cvt_pk_bf16_f32 v130, v130, v131
  v_cvt_pk_bf16_f32 v132, v132, v133
  v_cvt_pk_bf16_f32 v134, v134, v135
  s_add_u32 s51, s50, 0
  buffer_store_dword v120, v4, s[16:19], s51 offen offset:128 sc1
  s_add_u32 s51, s50, 8192
  buffer_store_dword v122, v4, s[16:19], s51 offen offset:128 sc1
  s_add_u32 s51, s50, 32768
  buffer_store_dword v124, v4, s[16:19], s51 offen offset:128 sc1
  s_add_u32 s51, s50, 40960
  buffer_store_dword v126, v4, s[16:19], s51 offen offset:128 sc1
  s_add_u32 s51, s50, 524288
  buffer_store_dword v128, v4, s[16:19], s51 offen offset:128 sc1
  s_add_u32 s51, s50, 532480
  buffer_store_dword v130, v4, s[16:19], s51 offen offset:128 sc1
  s_add_u32 s51, s50, 557056
  buffer_store_dword v132, v4, s[16:19], s51 offen offset:128 sc1
  s_add_u32 s51, s50, 565248
  buffer_store_dword v134, v4, s[16:19], s51 offen offset:128 sc1
  s_xor_b32 s50, s58, 1
  s_lshl_b32 s50, s50, 16
  s_add_u32 s50, s50, s48
  v_mul_f32 v152, v27, v152
  v_mul_f32 v153, v27, v153
  v_mul_f32 v154, v27, v154
  v_mul_f32 v155, v27, v155
  v_mul_f32 v156, v27, v156
  v_mul_f32 v157, v27, v157
  v_mul_f32 v158, v27, v158
  v_mul_f32 v159, v27, v159
  v_mul_f32 v160, v27, v160
  v_mul_f32 v161, v27, v161
  v_mul_f32 v162, v27, v162
  v_mul_f32 v163, v27, v163
  v_mul_f32 v164, v27, v164
  v_mul_f32 v165, v27, v165
  v_mul_f32 v166, v27, v166
  v_mul_f32 v167, v27, v167
  v_cvt_pk_bf16_f32 v152, v152, v153
  v_cvt_pk_bf16_f32 v154, v154, v155
  v_cvt_pk_bf16_f32 v156, v156, v157
  v_cvt_pk_bf16_f32 v158, v158, v159
  v_cvt_pk_bf16_f32 v160, v160, v161
  v_cvt_pk_bf16_f32 v162, v162, v163
  v_cvt_pk_bf16_f32 v164, v164, v165
  v_cvt_pk_bf16_f32 v166, v166, v167
  s_add_u32 s51, s50, 0
  buffer_store_dword v152, v4, s[16:19], s51 offen offset:128 sc1
  s_add_u32 s51, s50, 8192
  buffer_store_dword v154, v4, s[16:19], s51 offen offset:128 sc1
  s_add_u32 s51, s50, 32768
  buffer_store_dword v156, v4, s[16:19], s51 offen offset:128 sc1
  s_add_u32 s51, s50, 40960
  buffer_store_dword v158, v4, s[16:19], s51 offen offset:128 sc1
  s_add_u32 s51, s50, 524288
  buffer_store_dword v160, v4, s[16:19], s51 offen offset:128 sc1
  s_add_u32 s51, s50, 532480
  buffer_store_dword v162, v4, s[16:19], s51 offen offset:128 sc1
  s_add_u32 s51, s50, 557056
  buffer_store_dword v164, v4, s[16:19], s51 offen offset:128 sc1
  s_add_u32 s51, s50, 565248
  buffer_store_dword v166, v4, s[16:19], s51 offen offset:128 sc1
k1_kernel_done:
  s_endpgm

.globl k23_kernel
.p2align 8
.type k23_kernel,@function
k23_kernel:
k23_begin:
  s_cmp_ge_u32 s2, 256
  s_cbranch_scc1 k23_kernel_done
  s_load_dwordx2 s[26:27], s[0:1], 72
  s_load_dwordx2 s[24:25], s[0:1], 0
  s_load_dwordx4 s[28:31], s[0:1], 48
  v_lshrrev_b32 v1, 6, v0
  s_nop 0
  v_readfirstlane_b32 s36, v1
  v_and_b32 v1, 63, v0
  s_cmp_lt_u32 s36, 4
  s_cbranch_scc1 k23_kernel_gemm
  s_setprio 3
  s_sub_u32 s38, s36, 4
  s_lshl_b32 s38, s38, 4
  s_add_u32 s38, s38, 122880
  v_mov_b32 v14, s38
  v_mov_b32 v4, 0
  ds_write_b32 v14, v4
  ds_write_b32 v14, v4 offset:4
  ds_write_b32 v14, v4 offset:8
  ds_write_b32 v14, v4 offset:12
  v_xor_b32 v15, 16, v14
  v_mov_b32 v16, 1
  s_and_b32 s40, s36, 1
  s_bfe_u32 s41, s36, 0x10001
  s_lshl_b32 s39, s41, 8
  s_add_u32 s39, s39, s2
  v_and_b32 v2, 31, v1
  v_lshrrev_b32 v3, 5, v1
  v_lshlrev_b32 v11, 4, v1
  v_lshlrev_b32 v10, 7, v2
  v_lshl_add_u32 v10, v3, 6, v10
  s_and_b32 s37, s39, 255
  s_lshl_b32 s37, s37, 13
  s_lshl_b32 s38, s40, 12
  s_add_u32 s37, s37, s38
  s_add_u32 s37, s37, 8388608
  s_waitcnt lgkmcnt(0)
  s_barrier
  s_mov_b32 s12, s26
  s_and_b32 s13, s27, 0xffff
  s_mov_b32 s14, 18874368
  s_mov_b32 s15, 0x00020000
  s_mov_b32 s4, s24
  s_and_b32 s5, s25, 0xffff
  s_mov_b32 s6, 2097152
  s_mov_b32 s7, 0x00020000
  s_cmp_gt_u32 s39, 256
  s_cbranch_scc1 k23_kernel_nojob
  s_and_b32 s37, s39, 255
  s_lshl_b32 s37, s37, 13
  s_lshl_b32 s38, s40, 12
  s_add_u32 s37, s37, s38
  s_add_u32 s37, s37, 8388608
  buffer_load_dwordx4 v[20:23], v10, s[12:15], s37 offen offset:0
  buffer_load_dwordx4 v[24:27], v10, s[12:15], s37 offen offset:16
  buffer_load_dwordx4 v[28:31], v10, s[12:15], s37 offen offset:32
  buffer_load_dwordx4 v[32:35], v10, s[12:15], s37 offen offset:48
  s_lshl_b32 s37, s39, 13
  s_lshl_b32 s38, s40, 12
  s_add_u32 s37, s37, s38
  s_add_u32 s37, s37, 10485760
  buffer_load_dwordx4 v[36:39], v11, s[12:15], s37 offen offset:0
  buffer_load_dwordx4 v[40:43], v11, s[12:15], s37 offen offset:1024
  buffer_load_dwordx4 v[44:47], v11, s[12:15], s37 offen offset:2048
  buffer_load_dwordx4 v[48:51], v11, s[12:15], s37 offen offset:3072
  s_sub_u32 s37, s36, 4
  s_lshl_b32 s37, s37, 14
  v_add_u32 v13, s37, v11
  v_xor_b32 v12, 16384, v13
  v_bfe_u32 v4, v2, 2, 1
  v_lshlrev_b32 v4, 4, v4
  v_lshrrev_b32 v5, 3, v2
  v_lshl_add_u32 v4, v5, 2, v4
  v_and_b32 v5, 3, v2
  v_add_u32 v4, v4, v5
  v_cvt_f32_u32 v4, v4
  v_mul_f32 v4, 0x3a000000, v4
  v_mul_f32 v116, 0x42800000, v4
  v_lshlrev_b32 v117, 4, v3
  v_cvt_f32_u32 v117, v117
  v_mul_f32 v117, v117, v116
  v_fmamk_f32 v132, v116, 0x00000000, v117
  v_cos_f32 v133, v132
  v_sin_f32 v134, v132
  v_fmamk_f32 v135, v116, 0x3f800000, v117
  v_cvt_pk_bf16_f32 v52, v133, v134
  v_cvt_pk_bf16_f32 v68, -v134, v133
  v_cos_f32 v136, v135
  v_sin_f32 v137, v135
  v_fmamk_f32 v138, v116, 0x40000000, v117
  v_cvt_pk_bf16_f32 v53, v136, v137
  v_cvt_pk_bf16_f32 v69, -v137, v136
  v_cos_f32 v139, v138
  v_sin_f32 v140, v138
  v_fmamk_f32 v141, v116, 0x40400000, v117
  v_cvt_pk_bf16_f32 v54, v139, v140
  v_cvt_pk_bf16_f32 v70, -v140, v139
  v_cos_f32 v142, v141
  v_sin_f32 v143, v141
  v_fmamk_f32 v132, v116, 0x40800000, v117
  v_cvt_pk_bf16_f32 v55, v142, v143
  v_cvt_pk_bf16_f32 v71, -v143, v142
  v_cos_f32 v133, v132
  v_sin_f32 v134, v132
  v_fmamk_f32 v135, v116, 0x40a00000, v117
  v_cvt_pk_bf16_f32 v56, v133, v134
  v_cvt_pk_bf16_f32 v72, -v134, v133
  v_cos_f32 v136, v135
  v_sin_f32 v137, v135
  v_fmamk_f32 v138, v116, 0x40c00000, v117
  v_cvt_pk_bf16_f32 v57, v136, v137
  v_cvt_pk_bf16_f32 v73, -v137, v136
  v_cos_f32 v139, v138
  v_sin_f32 v140, v138
  v_fmamk_f32 v141, v116, 0x40e00000, v117
  v_cvt_pk_bf16_f32 v58, v139, v140
  v_cvt_pk_bf16_f32 v74, -v140, v139
  v_cos_f32 v142, v141
  v_sin_f32 v143, v141
  v_fmamk_f32 v132, v116, 0x41000000, v117
  v_cvt_pk_bf16_f32 v59, v142, v143
  v_cvt_pk_bf16_f32 v75, -v143, v142
  v_cos_f32 v133, v132
  v_sin_f32 v134, v132
  v_fmamk_f32 v135, v116, 0x41100000, v117
  v_cvt_pk_bf16_f32 v60, v133, v134
  v_cvt_pk_bf16_f32 v76, -v134, v133
  v_cos_f32 v136, v135
  v_sin_f32 v137, v135
  v_fmamk_f32 v138, v116, 0x41200000, v117
  v_cvt_pk_bf16_f32 v61, v136, v137
  v_cvt_pk_bf16_f32 v77, -v137, v136
  v_cos_f32 v139, v138
  v_sin_f32 v140, v138
  v_fmamk_f32 v141, v116, 0x41300000, v117
  v_cvt_pk_bf16_f32 v62, v139, v140
  v_cvt_pk_bf16_f32 v78, -v140, v139
  v_cos_f32 v142, v141
  v_sin_f32 v143, v141
  v_fmamk_f32 v132, v116, 0x41400000, v117
  v_cvt_pk_bf16_f32 v63, v142, v143
  v_cvt_pk_bf16_f32 v79, -v143, v142
  v_cos_f32 v133, v132
  v_sin_f32 v134, v132
  v_fmamk_f32 v135, v116, 0x41500000, v117
  v_cvt_pk_bf16_f32 v64, v133, v134
  v_cvt_pk_bf16_f32 v80, -v134, v133
  v_cos_f32 v136, v135
  v_sin_f32 v137, v135
  v_fmamk_f32 v138, v116, 0x41600000, v117
  v_cvt_pk_bf16_f32 v65, v136, v137
  v_cvt_pk_bf16_f32 v81, -v137, v136
  v_cos_f32 v139, v138
  v_sin_f32 v140, v138
  v_fmamk_f32 v141, v116, 0x41700000, v117
  v_cvt_pk_bf16_f32 v66, v139, v140
  v_cvt_pk_bf16_f32 v82, -v140, v139
  v_cos_f32 v142, v141
  v_sin_f32 v143, v141
  s_nop 0
  v_cvt_pk_bf16_f32 v67, v142, v143
  v_cvt_pk_bf16_f32 v83, -v143, v142
  s_lshl_b32 s37, s40, 5
  v_lshl_add_u32 v5, v3, 2, s37
  v_cvt_f32_u32 v5, v5
  v_mul_f32 v5, v5, v4
  v_fmamk_f32 v6, v4, 0x00000000, v5
  v_cos_f32 v180, v6
  v_sin_f32 v196, v6
  v_fmamk_f32 v7, v4, 0x3f800000, v5
  v_cos_f32 v181, v7
  v_sin_f32 v197, v7
  v_fmamk_f32 v8, v4, 0x40000000, v5
  v_cos_f32 v182, v8
  v_sin_f32 v198, v8
  v_fmamk_f32 v9, v4, 0x40400000, v5
  v_cos_f32 v183, v9
  v_sin_f32 v199, v9
  v_fmamk_f32 v6, v4, 0x41000000, v5
  v_cos_f32 v184, v6
  v_sin_f32 v200, v6
  v_fmamk_f32 v7, v4, 0x41100000, v5
  v_cos_f32 v185, v7
  v_sin_f32 v201, v7
  v_fmamk_f32 v8, v4, 0x41200000, v5
  v_cos_f32 v186, v8
  v_sin_f32 v202, v8
  v_fmamk_f32 v9, v4, 0x41300000, v5
  v_cos_f32 v187, v9
  v_sin_f32 v203, v9
  v_fmamk_f32 v6, v4, 0x41800000, v5
  v_cos_f32 v188, v6
  v_sin_f32 v204, v6
  v_fmamk_f32 v7, v4, 0x41880000, v5
  v_cos_f32 v189, v7
  v_sin_f32 v205, v7
  v_fmamk_f32 v8, v4, 0x41900000, v5
  v_cos_f32 v190, v8
  v_sin_f32 v206, v8
  v_fmamk_f32 v9, v4, 0x41980000, v5
  v_cos_f32 v191, v9
  v_sin_f32 v207, v9
  v_fmamk_f32 v6, v4, 0x41c00000, v5
  v_cos_f32 v192, v6
  v_sin_f32 v208, v6
  v_fmamk_f32 v7, v4, 0x41c80000, v5
  v_cos_f32 v193, v7
  v_sin_f32 v209, v7
  v_fmamk_f32 v8, v4, 0x41d00000, v5
  v_cos_f32 v194, v8
  v_sin_f32 v210, v8
  v_fmamk_f32 v9, v4, 0x41d80000, v5
  v_cos_f32 v195, v9
  v_sin_f32 v211, v9
  v_add_u32 v116, s37, v2
  v_cvt_f32_u32 v116, v116
  v_mul_f32 v116, 0x3c800000, v116
  v_lshl_add_u32 v117, v3, 2, s37
  v_cvt_f32_u32 v117, v117
  v_mul_f32 v117, v117, v116
  v_fmamk_f32 v132, v116, 0x00000000, v117
  v_cos_f32 v133, v132
  v_sin_f32 v134, v132
  v_fmamk_f32 v135, v116, 0x3f800000, v117
  v_cos_f32 v136, v135
  v_sin_f32 v137, v135
  v_fmamk_f32 v138, v116, 0x40000000, v117
  v_cvt_pk_bf16_f32 v84, v133, v136
  v_cvt_pk_bf16_f32 v100, -v134, -v137
  v_cos_f32 v139, v138
  v_sin_f32 v140, v138
  v_fmamk_f32 v141, v116, 0x40400000, v117
  v_cos_f32 v142, v141
  v_sin_f32 v143, v141
  v_fmamk_f32 v132, v116, 0x41000000, v117
  v_cvt_pk_bf16_f32 v85, v139, v142
  v_cvt_pk_bf16_f32 v101, -v140, -v143
  v_cos_f32 v133, v132
  v_sin_f32 v134, v132
  v_fmamk_f32 v135, v116, 0x41100000, v117
  v_cos_f32 v136, v135
  v_sin_f32 v137, v135
  v_fmamk_f32 v138, v116, 0x41200000, v117
  v_cvt_pk_bf16_f32 v86, v133, v136
  v_cvt_pk_bf16_f32 v102, -v134, -v137
  v_cos_f32 v139, v138
  v_sin_f32 v140, v138
  v_fmamk_f32 v141, v116, 0x41300000, v117
  v_cos_f32 v142, v141
  v_sin_f32 v143, v141
  v_fmamk_f32 v132, v116, 0x41800000, v117
  v_cvt_pk_bf16_f32 v87, v139, v142
  v_cvt_pk_bf16_f32 v103, -v140, -v143
  v_cos_f32 v133, v132
  v_sin_f32 v134, v132
  v_fmamk_f32 v135, v116, 0x41880000, v117
  v_cos_f32 v136, v135
  v_sin_f32 v137, v135
  v_fmamk_f32 v138, v116, 0x41900000, v117
  v_cvt_pk_bf16_f32 v88, v133, v136
  v_cvt_pk_bf16_f32 v104, -v134, -v137
  v_cos_f32 v139, v138
  v_sin_f32 v140, v138
  v_fmamk_f32 v141, v116, 0x41980000, v117
  v_cos_f32 v142, v141
  v_sin_f32 v143, v141
  v_fmamk_f32 v132, v116, 0x41c00000, v117
  v_cvt_pk_bf16_f32 v89, v139, v142
  v_cvt_pk_bf16_f32 v105, -v140, -v143
  v_cos_f32 v133, v132
  v_sin_f32 v134, v132
  v_fmamk_f32 v135, v116, 0x41c80000, v117
  v_cos_f32 v136, v135
  v_sin_f32 v137, v135
  v_fmamk_f32 v138, v116, 0x41d00000, v117
  v_cvt_pk_bf16_f32 v90, v133, v136
  v_cvt_pk_bf16_f32 v106, -v134, -v137
  v_cos_f32 v139, v138
  v_sin_f32 v140, v138
  v_fmamk_f32 v141, v116, 0x41d80000, v117
  v_cos_f32 v142, v141
  v_sin_f32 v143, v141
  v_fmamk_f32 v132, v116, 0x42000000, v117
  v_cvt_pk_bf16_f32 v91, v139, v142
  v_cvt_pk_bf16_f32 v107, -v140, -v143
  v_cos_f32 v133, v132
  v_sin_f32 v134, v132
  v_fmamk_f32 v135, v116, 0x42040000, v117
  v_cos_f32 v136, v135
  v_sin_f32 v137, v135
  v_fmamk_f32 v138, v116, 0x42080000, v117
  v_cvt_pk_bf16_f32 v92, v133, v136
  v_cvt_pk_bf16_f32 v108, -v134, -v137
  v_cos_f32 v139, v138
  v_sin_f32 v140, v138
  v_fmamk_f32 v141, v116, 0x420c0000, v117
  v_cos_f32 v142, v141
  v_sin_f32 v143, v141
  v_fmamk_f32 v132, v116, 0x42200000, v117
  v_cvt_pk_bf16_f32 v93, v139, v142
  v_cvt_pk_bf16_f32 v109, -v140, -v143
  v_cos_f32 v133, v132
  v_sin_f32 v134, v132
  v_fmamk_f32 v135, v116, 0x42240000, v117
  v_cos_f32 v136, v135
  v_sin_f32 v137, v135
  v_fmamk_f32 v138, v116, 0x42280000, v117
  v_cvt_pk_bf16_f32 v94, v133, v136
  v_cvt_pk_bf16_f32 v110, -v134, -v137
  v_cos_f32 v139, v138
  v_sin_f32 v140, v138
  v_fmamk_f32 v141, v116, 0x422c0000, v117
  v_cos_f32 v142, v141
  v_sin_f32 v143, v141
  v_fmamk_f32 v132, v116, 0x42400000, v117
  v_cvt_pk_bf16_f32 v95, v139, v142
  v_cvt_pk_bf16_f32 v111, -v140, -v143
  v_cos_f32 v133, v132
  v_sin_f32 v134, v132
  v_fmamk_f32 v135, v116, 0x42440000, v117
  v_cos_f32 v136, v135
  v_sin_f32 v137, v135
  v_fmamk_f32 v138, v116, 0x42480000, v117
  v_cvt_pk_bf16_f32 v96, v133, v136
  v_cvt_pk_bf16_f32 v112, -v134, -v137
  v_cos_f32 v139, v138
  v_sin_f32 v140, v138
  v_fmamk_f32 v141, v116, 0x424c0000, v117
  v_cos_f32 v142, v141
  v_sin_f32 v143, v141
  v_fmamk_f32 v132, v116, 0x42600000, v117
  v_cvt_pk_bf16_f32 v97, v139, v142
  v_cvt_pk_bf16_f32 v113, -v140, -v143
  v_cos_f32 v133, v132
  v_sin_f32 v134, v132
  v_fmamk_f32 v135, v116, 0x42640000, v117
  v_cos_f32 v136, v135
  v_sin_f32 v137, v135
  v_fmamk_f32 v138, v116, 0x42680000, v117
  v_cvt_pk_bf16_f32 v98, v133, v136
  v_cvt_pk_bf16_f32 v114, -v134, -v137
  v_cos_f32 v139, v138
  v_sin_f32 v140, v138
  v_fmamk_f32 v141, v116, 0x426c0000, v117
  v_cos_f32 v142, v141
  v_sin_f32 v143, v141
  s_nop 0
  v_cvt_pk_bf16_f32 v99, v139, v142
  v_cvt_pk_bf16_f32 v115, -v140, -v143
  s_waitcnt vmcnt(4)
  s_and_b32 s37, s39, 255
  s_cmp_lg_u32 s37, 0
  s_cbranch_scc1 k23_kernel_nospec
  s_lshr_b32 s37, s39, 4
  v_lshrrev_b32 v20, s37, v20
  v_and_b32 v20, 0xffff, v20
  v_lshrrev_b32 v21, s37, v21
  v_and_b32 v21, 0xffff, v21
  v_lshrrev_b32 v22, s37, v22
  v_and_b32 v22, 0xffff, v22
  v_lshrrev_b32 v23, s37, v23
  v_and_b32 v23, 0xffff, v23
  v_lshrrev_b32 v24, s37, v24
  v_and_b32 v24, 0xffff, v24
  v_lshrrev_b32 v25, s37, v25
  v_and_b32 v25, 0xffff, v25
  v_lshrrev_b32 v26, s37, v26
  v_and_b32 v26, 0xffff, v26
  v_lshrrev_b32 v27, s37, v27
  v_and_b32 v27, 0xffff, v27
  v_lshrrev_b32 v28, s37, v28
  v_and_b32 v28, 0xffff, v28
  v_lshrrev_b32 v29, s37, v29
  v_and_b32 v29, 0xffff, v29
  v_lshrrev_b32 v30, s37, v30
  v_and_b32 v30, 0xffff, v30
  v_lshrrev_b32 v31, s37, v31
  v_and_b32 v31, 0xffff, v31
  v_lshrrev_b32 v32, s37, v32
  v_and_b32 v32, 0xffff, v32
  v_lshrrev_b32 v33, s37, v33
  v_and_b32 v33, 0xffff, v33
  v_lshrrev_b32 v34, s37, v34
  v_and_b32 v34, 0xffff, v34
  v_lshrrev_b32 v35, s37, v35
  v_and_b32 v35, 0xffff, v35
k23_kernel_nospec:
  v_mfma_f32_32x32x16_bf16 v[116:131], v[20:23], v[52:55], 0
  v_mfma_f32_32x32x16_bf16 v[132:147], v[20:23], v[68:71], 0
  v_mfma_f32_32x32x16_bf16 v[116:131], v[24:27], v[56:59], v[116:131]
  v_mfma_f32_32x32x16_bf16 v[132:147], v[24:27], v[72:75], v[132:147]
  v_mfma_f32_32x32x16_bf16 v[116:131], v[28:31], v[60:63], v[116:131]
  v_mfma_f32_32x32x16_bf16 v[132:147], v[28:31], v[76:79], v[132:147]
  v_mfma_f32_32x32x16_bf16 v[116:131], v[32:35], v[64:67], v[116:131]
  v_mfma_f32_32x32x16_bf16 v[132:147], v[32:35], v[80:83], v[132:147]
  s_nop 11
  v_mul_f32 v4, v132, v196
  v_mul_f32 v132, v132, v180
  v_fma_f32 v132, -v116, v196, v132
  v_fma_f32 v116, v116, v180, v4
  v_mul_f32 v5, v133, v197
  v_mul_f32 v133, v133, v181
  v_fma_f32 v133, -v117, v197, v133
  v_fma_f32 v117, v117, v181, v5
  v_mul_f32 v6, v134, v198
  v_mul_f32 v134, v134, v182
  v_fma_f32 v134, -v118, v198, v134
  v_fma_f32 v118, v118, v182, v6
  v_mul_f32 v7, v135, v199
  v_mul_f32 v135, v135, v183
  v_fma_f32 v135, -v119, v199, v135
  v_fma_f32 v119, v119, v183, v7
  v_mul_f32 v4, v136, v200
  v_mul_f32 v136, v136, v184
  v_fma_f32 v136, -v120, v200, v136
  v_fma_f32 v120, v120, v184, v4
  v_mul_f32 v5, v137, v201
  v_mul_f32 v137, v137, v185
  v_fma_f32 v137, -v121, v201, v137
  v_fma_f32 v121, v121, v185, v5
  v_mul_f32 v6, v138, v202
  v_mul_f32 v138, v138, v186
  v_fma_f32 v138, -v122, v202, v138
  v_fma_f32 v122, v122, v186, v6
  v_mul_f32 v7, v139, v203
  v_mul_f32 v139, v139, v187
  v_fma_f32 v139, -v123, v203, v139
  v_fma_f32 v123, v123, v187, v7
  v_mul_f32 v4, v140, v204
  v_mul_f32 v140, v140, v188
  v_fma_f32 v140, -v124, v204, v140
  v_fma_f32 v124, v124, v188, v4
  v_mul_f32 v5, v141, v205
  v_mul_f32 v141, v141, v189
  v_fma_f32 v141, -v125, v205, v141
  v_fma_f32 v125, v125, v189, v5
  v_mul_f32 v6, v142, v206
  v_mul_f32 v142, v142, v190
  v_fma_f32 v142, -v126, v206, v142
  v_fma_f32 v126, v126, v190, v6
  v_mul_f32 v7, v143, v207
  v_mul_f32 v143, v143, v191
  v_fma_f32 v143, -v127, v207, v143
  v_fma_f32 v127, v127, v191, v7
  v_mul_f32 v4, v144, v208
  v_mul_f32 v144, v144, v192
  v_fma_f32 v144, -v128, v208, v144
  v_fma_f32 v128, v128, v192, v4
  v_mul_f32 v5, v145, v209
  v_mul_f32 v145, v145, v193
  v_fma_f32 v145, -v129, v209, v145
  v_fma_f32 v129, v129, v193, v5
  v_mul_f32 v6, v146, v210
  v_mul_f32 v146, v146, v194
  v_fma_f32 v146, -v130, v210, v146
  v_fma_f32 v130, v130, v194, v6
  v_mul_f32 v7, v147, v211
  v_mul_f32 v147, v147, v195
  v_fma_f32 v147, -v131, v211, v147
  v_fma_f32 v131, v131, v195, v7
  v_cvt_pk_bf16_f32 v148, v116, v117
  v_cvt_pk_bf16_f32 v164, v132, v133
  v_cvt_pk_bf16_f32 v149, v118, v119
  v_cvt_pk_bf16_f32 v165, v134, v135
  v_cvt_pk_bf16_f32 v150, v120, v121
  v_cvt_pk_bf16_f32 v166, v136, v137
  v_cvt_pk_bf16_f32 v151, v122, v123
  v_cvt_pk_bf16_f32 v167, v138, v139
  v_cvt_pk_bf16_f32 v152, v124, v125
  v_cvt_pk_bf16_f32 v168, v140, v141
  v_cvt_pk_bf16_f32 v153, v126, v127
  v_cvt_pk_bf16_f32 v169, v142, v143
  v_cvt_pk_bf16_f32 v154, v128, v129
  v_cvt_pk_bf16_f32 v170, v144, v145
  v_cvt_pk_bf16_f32 v155, v130, v131
  v_cvt_pk_bf16_f32 v171, v146, v147
  ds_write_b128 v12, v[148:151] offset:0
  ds_write_b128 v12, v[152:155] offset:1024
  ds_write_b128 v12, v[164:167] offset:2048
  ds_write_b128 v12, v[168:171] offset:3072
  ds_write_b32 v14, v16 offset:0
  v_xor_b32 v20, 0x80008000, v164
  v_xor_b32 v21, 0x80008000, v165
  v_xor_b32 v22, 0x80008000, v166
  v_xor_b32 v23, 0x80008000, v167
  v_xor_b32 v24, 0x80008000, v168
  v_xor_b32 v25, 0x80008000, v169
  v_xor_b32 v26, 0x80008000, v170
  v_xor_b32 v27, 0x80008000, v171
  v_mfma_f32_32x32x16_bf16 v[116:131], v[84:87], v[148:151], 0
  v_mfma_f32_32x32x16_bf16 v[132:147], v[100:103], v[148:151], 0
  v_mfma_f32_32x32x16_bf16 v[132:147], v[84:87], v[164:167], v[132:147]
  v_mfma_f32_32x32x16_bf16 v[116:131], v[100:103], v[20:23], v[116:131]
k23_kernel_sp0:
  ds_read_b32 v4, v15 offset:0
  s_waitcnt lgkmcnt(0)
  v_readfirstlane_b32 s37, v4
  s_cmp_eq_u32 s37, 0
  s_cbranch_scc1 k23_kernel_sp0
  ds_read_b128 v[172:175], v13 offset:2048
  ds_read_b128 v[176:179], v13 offset:3072
  ds_read_b128 v[156:159], v13 offset:0
  ds_read_b128 v[160:163], v13 offset:1024
  v_mfma_f32_32x32x16_bf16 v[116:131], v[88:91], v[152:155], v[116:131]
  v_mfma_f32_32x32x16_bf16 v[132:147], v[104:107], v[152:155], v[132:147]
  v_mfma_f32_32x32x16_bf16 v[132:147], v[88:91], v[168:171], v[132:147]
  v_mfma_f32_32x32x16_bf16 v[116:131], v[104:107], v[24:27], v[116:131]
  s_waitcnt lgkmcnt(2)
  v_xor_b32 v28, 0x80008000, v172
  v_xor_b32 v29, 0x80008000, v173
  v_xor_b32 v30, 0x80008000, v174
  v_xor_b32 v31, 0x80008000, v175
  v_xor_b32 v32, 0x80008000, v176
  v_xor_b32 v33, 0x80008000, v177
  v_xor_b32 v34, 0x80008000, v178
  v_xor_b32 v35, 0x80008000, v179
  s_waitcnt lgkmcnt(0)
  s_lshl_b32 s38, s40, 5
  v_add_u32 v4, s38, v2
  v_cvt_f32_u32 v4, v4
  v_mul_f32 v4, 0x3a000000, v4
  v_lshlrev_b32 v5, 4, v3
  v_cvt_f32_u32 v5, v5
  v_mul_f32 v5, v5, v4
  v_mfma_f32_32x32x16_bf16 v[116:131], v[92:95], v[156:159], v[116:131]
  v_fmamk_f32 v6, v4, 0x00000000, v5
  v_cos_f32 v212, v6
  v_sin_f32 v228, v6
  v_fmamk_f32 v7, v4, 0x3f800000, v5
  v_cos_f32 v213, v7
  v_sin_f32 v229, v7
  v_mfma_f32_32x32x16_bf16 v[132:147], v[108:111], v[156:159], v[132:147]
  v_fmamk_f32 v8, v4, 0x40000000, v5
  v_cos_f32 v214, v8
  v_sin_f32 v230, v8
  v_fmamk_f32 v9, v4, 0x40400000, v5
  v_cos_f32 v215, v9
  v_sin_f32 v231, v9
  v_mfma_f32_32x32x16_bf16 v[132:147], v[92:95], v[172:175], v[132:147]
  v_fmamk_f32 v6, v4, 0x40800000, v5
  v_cos_f32 v216, v6
  v_sin_f32 v232, v6
  v_fmamk_f32 v7, v4, 0x40a00000, v5
  v_cos_f32 v217, v7
  v_sin_f32 v233, v7
  v_mfma_f32_32x32x16_bf16 v[116:131], v[108:111], v[28:31], v[116:131]
  v_fmamk_f32 v8, v4, 0x40c00000, v5
  v_cos_f32 v218, v8
  v_sin_f32 v234, v8
  v_fmamk_f32 v9, v4, 0x40e00000, v5
  v_cos_f32 v219, v9
  v_sin_f32 v235, v9
  v_mfma_f32_32x32x16_bf16 v[116:131], v[96:99], v[160:163], v[116:131]
  v_fmamk_f32 v6, v4, 0x41000000, v5
  v_cos_f32 v220, v6
  v_sin_f32 v236, v6
  v_fmamk_f32 v7, v4, 0x41100000, v5
  v_cos_f32 v221, v7
  v_sin_f32 v237, v7
  v_mfma_f32_32x32x16_bf16 v[132:147], v[112:115], v[160:163], v[132:147]
  v_fmamk_f32 v8, v4, 0x41200000, v5
  v_cos_f32 v222, v8
  v_sin_f32 v238, v8
  v_fmamk_f32 v9, v4, 0x41300000, v5
  v_cos_f32 v223, v9
  v_sin_f32 v239, v9
  v_mfma_f32_32x32x16_bf16 v[132:147], v[96:99], v[176:179], v[132:147]
  v_fmamk_f32 v6, v4, 0x41400000, v5
  v_cos_f32 v224, v6
  v_sin_f32 v240, v6
  v_fmamk_f32 v7, v4, 0x41500000, v5
  v_cos_f32 v225, v7
  v_sin_f32 v241, v7
  v_mfma_f32_32x32x16_bf16 v[116:131], v[112:115], v[32:35], v[116:131]
  v_fmamk_f32 v8, v4, 0x41600000, v5
  v_cos_f32 v226, v8
  v_sin_f32 v242, v8
  v_fmamk_f32 v9, v4, 0x41700000, v5
  v_cos_f32 v227, v9
  v_sin_f32 v243, v9
  s_waitcnt vmcnt(0)
  v_lshlrev_b32 v180, 16, v36
  v_and_b32 v196, 0xffff0000, v36
  v_lshlrev_b32 v181, 16, v37
  v_and_b32 v197, 0xffff0000, v37
  v_lshlrev_b32 v182, 16, v38
  v_and_b32 v198, 0xffff0000, v38
  v_lshlrev_b32 v183, 16, v39
  v_and_b32 v199, 0xffff0000, v39
  v_lshlrev_b32 v184, 16, v40
  v_and_b32 v200, 0xffff0000, v40
  v_lshlrev_b32 v185, 16, v41
  v_and_b32 v201, 0xffff0000, v41
  v_lshlrev_b32 v186, 16, v42
  v_and_b32 v202, 0xffff0000, v42
  v_lshlrev_b32 v187, 16, v43
  v_and_b32 v203, 0xffff0000, v43
  v_lshlrev_b32 v188, 16, v44
  v_and_b32 v204, 0xffff0000, v44
  v_lshlrev_b32 v189, 16, v45
  v_and_b32 v205, 0xffff0000, v45
  v_lshlrev_b32 v190, 16, v46
  v_and_b32 v206, 0xffff0000, v46
  v_lshlrev_b32 v191, 16, v47
  v_and_b32 v207, 0xffff0000, v47
  v_lshlrev_b32 v192, 16, v48
  v_and_b32 v208, 0xffff0000, v48
  v_lshlrev_b32 v193, 16, v49
  v_and_b32 v209, 0xffff0000, v49
  v_lshlrev_b32 v194, 16, v50
  v_and_b32 v210, 0xffff0000, v50
  v_lshlrev_b32 v195, 16, v51
  v_and_b32 v211, 0xffff0000, v51
  v_mul_f32 v4, v132, v196
  v_mul_f32 v132, v132, v180
  v_fma_f32 v132, v116, v196, v132
  v_fma_f32 v116, v116, v180, -v4
  v_mul_f32 v5, v133, v197
  v_mul_f32 v133, v133, v181
  v_fma_f32 v133, v117, v197, v133
  v_fma_f32 v117, v117, v181, -v5
  v_mul_f32 v6, v134, v198
  v_mul_f32 v134, v134, v182
  v_fma_f32 v134, v118, v198, v134
  v_fma_f32 v118, v118, v182, -v6
  v_mul_f32 v7, v135, v199
  v_mul_f32 v135, v135, v183
  v_fma_f32 v135, v119, v199, v135
  v_fma_f32 v119, v119, v183, -v7
  v_mul_f32 v4, v136, v200
  v_mul_f32 v136, v136, v184
  v_fma_f32 v136, v120, v200, v136
  v_fma_f32 v120, v120, v184, -v4
  v_mul_f32 v5, v137, v201
  v_mul_f32 v137, v137, v185
  v_fma_f32 v137, v121, v201, v137
  v_fma_f32 v121, v121, v185, -v5
  v_mul_f32 v6, v138, v202
  v_mul_f32 v138, v138, v186
  v_fma_f32 v138, v122, v202, v138
  v_fma_f32 v122, v122, v186, -v6
  v_mul_f32 v7, v139, v203
  v_mul_f32 v139, v139, v187
  v_fma_f32 v139, v123, v203, v139
  v_fma_f32 v123, v123, v187, -v7
  v_mul_f32 v4, v140, v204
  v_mul_f32 v140, v140, v188
  v_fma_f32 v140, v124, v204, v140
  v_fma_f32 v124, v124, v188, -v4
  v_mul_f32 v5, v141, v205
  v_mul_f32 v141, v141, v189
  v_fma_f32 v141, v125, v205, v141
  v_fma_f32 v125, v125, v189, -v5
  v_mul_f32 v6, v142, v206
  v_mul_f32 v142, v142, v190
  v_fma_f32 v142, v126, v206, v142
  v_fma_f32 v126, v126, v190, -v6
  v_mul_f32 v7, v143, v207
  v_mul_f32 v143, v143, v191
  v_fma_f32 v143, v127, v207, v143
  v_fma_f32 v127, v127, v191, -v7
  v_mul_f32 v4, v144, v208
  v_mul_f32 v144, v144, v192
  v_fma_f32 v144, v128, v208, v144
  v_fma_f32 v128, v128, v192, -v4
  v_mul_f32 v5, v145, v209
  v_mul_f32 v145, v145, v193
  v_fma_f32 v145, v129, v209, v145
  v_fma_f32 v129, v129, v193, -v5
  v_mul_f32 v6, v146, v210
  v_mul_f32 v146, v146, v194
  v_fma_f32 v146, v130, v210, v146
  v_fma_f32 v130, v130, v194, -v6
  v_mul_f32 v7, v147, v211
  v_mul_f32 v147, v147, v195
  v_fma_f32 v147, v131, v211, v147
  v_fma_f32 v131, v131, v195, -v7
  v_cvt_pk_bf16_f32 v148, v116, v117
  v_cvt_pk_bf16_f32 v164, v132, v133
  v_cvt_pk_bf16_f32 v149, v118, v119
  v_cvt_pk_bf16_f32 v165, v134, v135
  v_cvt_pk_bf16_f32 v150, v120, v121
  v_cvt_pk_bf16_f32 v166, v136, v137
  v_cvt_pk_bf16_f32 v151, v122, v123
  v_cvt_pk_bf16_f32 v167, v138, v139
  v_cvt_pk_bf16_f32 v152, v124, v125
  v_cvt_pk_bf16_f32 v168, v140, v141
  v_cvt_pk_bf16_f32 v153, v126, v127
  v_cvt_pk_bf16_f32 v169, v142, v143
  v_cvt_pk_bf16_f32 v154, v128, v129
  v_cvt_pk_bf16_f32 v170, v144, v145
  v_cvt_pk_bf16_f32 v155, v130, v131
  v_cvt_pk_bf16_f32 v171, v146, v147
  ds_write_b128 v12, v[148:151] offset:8192
  ds_write_b128 v12, v[152:155] offset:9216
  ds_write_b128 v12, v[164:167] offset:10240
  ds_write_b128 v12, v[168:171] offset:11264
  ds_write_b32 v14, v16 offset:4
  v_xor_b32 v20, 0x80008000, v148
  v_xor_b32 v21, 0x80008000, v149
  v_xor_b32 v22, 0x80008000, v150
  v_xor_b32 v23, 0x80008000, v151
  v_xor_b32 v24, 0x80008000, v152
  v_xor_b32 v25, 0x80008000, v153
  v_xor_b32 v26, 0x80008000, v154
  v_xor_b32 v27, 0x80008000, v155
  s_nop 0
  v_mfma_f32_32x32x16_bf16 v[116:131], v[148:151], v[84:87], 0
  v_mfma_f32_32x32x16_bf16 v[132:147], v[164:167], v[84:87], 0
  v_mfma_f32_32x32x16_bf16 v[116:131], v[164:167], v[100:103], v[116:131]
  v_mfma_f32_32x32x16_bf16 v[132:147], v[20:23], v[100:103], v[132:147]
k23_kernel_sp1:
  ds_read_b32 v4, v15 offset:4
  s_waitcnt lgkmcnt(0)
  v_readfirstlane_b32 s37, v4
  s_cmp_eq_u32 s37, 0
  s_cbranch_scc1 k23_kernel_sp1
  ds_read_b128 v[156:159], v13 offset:8192
  ds_read_b128 v[160:163], v13 offset:9216
  ds_read_b128 v[172:175], v13 offset:10240
  ds_read_b128 v[176:179], v13 offset:11264
  v_mfma_f32_32x32x16_bf16 v[116:131], v[152:155], v[88:91], v[116:131]
  v_mfma_f32_32x32x16_bf16 v[132:147], v[168:171], v[88:91], v[132:147]
  v_mfma_f32_32x32x16_bf16 v[116:131], v[168:171], v[104:107], v[116:131]
  v_mfma_f32_32x32x16_bf16 v[132:147], v[24:27], v[104:107], v[132:147]
  s_waitcnt lgkmcnt(2)
  v_xor_b32 v28, 0x80008000, v156
  v_xor_b32 v29, 0x80008000, v157
  v_xor_b32 v30, 0x80008000, v158
  v_xor_b32 v31, 0x80008000, v159
  v_xor_b32 v32, 0x80008000, v160
  v_xor_b32 v33, 0x80008000, v161
  v_xor_b32 v34, 0x80008000, v162
  v_xor_b32 v35, 0x80008000, v163
  s_waitcnt lgkmcnt(0)
  v_mfma_f32_32x32x16_bf16 v[116:131], v[156:159], v[92:95], v[116:131]
  v_mfma_f32_32x32x16_bf16 v[132:147], v[172:175], v[92:95], v[132:147]
  v_mfma_f32_32x32x16_bf16 v[116:131], v[172:175], v[108:111], v[116:131]
  v_mfma_f32_32x32x16_bf16 v[132:147], v[28:31], v[108:111], v[132:147]
  v_mfma_f32_32x32x16_bf16 v[116:131], v[160:163], v[96:99], v[116:131]
  v_mfma_f32_32x32x16_bf16 v[132:147], v[176:179], v[96:99], v[132:147]
  v_mfma_f32_32x32x16_bf16 v[116:131], v[176:179], v[112:115], v[116:131]
  v_mfma_f32_32x32x16_bf16 v[132:147], v[32:35], v[112:115], v[132:147]
  s_nop 11
  v_mul_f32 v4, v132, v228
  v_mul_f32 v132, v132, v212
  v_fma_f32 v132, v116, v228, v132
  v_fma_f32 v116, v116, v212, -v4
  v_mul_f32 v5, v133, v229
  v_mul_f32 v133, v133, v213
  v_fma_f32 v133, v117, v229, v133
  v_fma_f32 v117, v117, v213, -v5
  v_mul_f32 v6, v134, v230
  v_mul_f32 v134, v134, v214
  v_fma_f32 v134, v118, v230, v134
  v_fma_f32 v118, v118, v214, -v6
  v_mul_f32 v7, v135, v231
  v_mul_f32 v135, v135, v215
  v_fma_f32 v135, v119, v231, v135
  v_fma_f32 v119, v119, v215, -v7
  v_mul_f32 v4, v136, v232
  v_mul_f32 v136, v136, v216
  v_fma_f32 v136, v120, v232, v136
  v_fma_f32 v120, v120, v216, -v4
  v_mul_f32 v5, v137, v233
  v_mul_f32 v137, v137, v217
  v_fma_f32 v137, v121, v233, v137
  v_fma_f32 v121, v121, v217, -v5
  v_mul_f32 v6, v138, v234
  v_mul_f32 v138, v138, v218
  v_fma_f32 v138, v122, v234, v138
  v_fma_f32 v122, v122, v218, -v6
  v_mul_f32 v7, v139, v235
  v_mul_f32 v139, v139, v219
  v_fma_f32 v139, v123, v235, v139
  v_fma_f32 v123, v123, v219, -v7
  v_mul_f32 v4, v140, v236
  v_mul_f32 v140, v140, v220
  v_fma_f32 v140, v124, v236, v140
  v_fma_f32 v124, v124, v220, -v4
  v_mul_f32 v5, v141, v237
  v_mul_f32 v141, v141, v221
  v_fma_f32 v141, v125, v237, v141
  v_fma_f32 v125, v125, v221, -v5
  v_mul_f32 v6, v142, v238
  v_mul_f32 v142, v142, v222
  v_fma_f32 v142, v126, v238, v142
  v_fma_f32 v126, v126, v222, -v6
  v_mul_f32 v7, v143, v239
  v_mul_f32 v143, v143, v223
  v_fma_f32 v143, v127, v239, v143
  v_fma_f32 v127, v127, v223, -v7
  v_mul_f32 v4, v144, v240
  v_mul_f32 v144, v144, v224
  v_fma_f32 v144, v128, v240, v144
  v_fma_f32 v128, v128, v224, -v4
  v_mul_f32 v5, v145, v241
  v_mul_f32 v145, v145, v225
  v_fma_f32 v145, v129, v241, v145
  v_fma_f32 v129, v129, v225, -v5
  v_mul_f32 v6, v146, v242
  v_mul_f32 v146, v146, v226
  v_fma_f32 v146, v130, v242, v146
  v_fma_f32 v130, v130, v226, -v6
  v_mul_f32 v7, v147, v243
  v_mul_f32 v147, v147, v227
  v_fma_f32 v147, v131, v243, v147
  v_fma_f32 v131, v131, v227, -v7
  v_cvt_pk_bf16_f32 v148, v116, -v132
  v_cvt_pk_bf16_f32 v149, v117, -v133
  v_cvt_pk_bf16_f32 v150, v118, -v134
  v_cvt_pk_bf16_f32 v151, v119, -v135
  v_cvt_pk_bf16_f32 v152, v120, -v136
  v_cvt_pk_bf16_f32 v153, v121, -v137
  v_cvt_pk_bf16_f32 v154, v122, -v138
  v_cvt_pk_bf16_f32 v155, v123, -v139
  v_cvt_pk_bf16_f32 v156, v124, -v140
  v_cvt_pk_bf16_f32 v157, v125, -v141
  v_cvt_pk_bf16_f32 v158, v126, -v142
  v_cvt_pk_bf16_f32 v159, v127, -v143
  v_cvt_pk_bf16_f32 v160, v128, -v144
  v_cvt_pk_bf16_f32 v161, v129, -v145
  v_cvt_pk_bf16_f32 v162, v130, -v146
  v_cvt_pk_bf16_f32 v163, v131, -v147
  s_nop 1
  v_mfma_f32_32x32x16_bf16 v[116:131], v[52:55], v[148:151], 0
  v_mfma_f32_32x32x16_bf16 v[116:131], v[56:59], v[152:155], v[116:131]
  v_mfma_f32_32x32x16_bf16 v[116:131], v[60:63], v[156:159], v[116:131]
  v_mfma_f32_32x32x16_bf16 v[116:131], v[64:67], v[160:163], v[116:131]
  v_mfma_f32_32x32x16_bf16 v[132:147], v[68:71], v[148:151], 0
  v_mfma_f32_32x32x16_bf16 v[132:147], v[72:75], v[152:155], v[132:147]
  v_mfma_f32_32x32x16_bf16 v[132:147], v[76:79], v[156:159], v[132:147]
  v_mfma_f32_32x32x16_bf16 v[132:147], v[80:83], v[160:163], v[132:147]
  v_lshlrev_b32 v4, 6, v2
  v_lshl_add_u32 v4, v3, 5, v4
  s_and_b32 s37, s39, 255
  s_lshl_b32 s37, s37, 8
  s_lshr_b32 s38, s39, 8
  s_lshl_b32 s38, s38, 7
  s_add_u32 s37, s37, s38
  s_lshl_b32 s38, s40, 20
  s_add_u32 s37, s37, s38
  s_add_u32 s37, s37, 13631488
  s_add_u32 s38, s37, 524288
  v_lshrrev_b32 v6, 3, v1
  v_and_b32 v7, 7, v1
  v_lshlrev_b32 v6, 16, v6
  v_lshl_add_u32 v6, v7, 4, v6
  v_sub_u32 v5, v13, v11
  v_add_u32 v4, v4, v5
  v_cvt_pk_bf16_f32 v164, v116, v117
  v_cvt_pk_bf16_f32 v165, v118, v119
  v_cvt_pk_bf16_f32 v166, v120, v121
  v_cvt_pk_bf16_f32 v167, v122, v123
  v_cvt_pk_bf16_f32 v168, v124, v125
  v_cvt_pk_bf16_f32 v169, v126, v127
  v_cvt_pk_bf16_f32 v170, v128, v129
  v_cvt_pk_bf16_f32 v171, v130, v131
  ds_write_b128 v4, v[164:167] offset:0
  ds_write_b128 v4, v[168:171] offset:16
  ds_read_b128 v[172:175], v13 offset:0
  ds_read_b128 v[176:179], v13 offset:1024
  v_cvt_pk_bf16_f32 v20, -v132, -v133
  v_cvt_pk_bf16_f32 v21, -v134, -v135
  v_cvt_pk_bf16_f32 v22, -v136, -v137
  v_cvt_pk_bf16_f32 v23, -v138, -v139
  v_cvt_pk_bf16_f32 v24, -v140, -v141
  v_cvt_pk_bf16_f32 v25, -v142, -v143
  v_cvt_pk_bf16_f32 v26, -v144, -v145
  v_cvt_pk_bf16_f32 v27, -v146, -v147
  ds_write_b128 v4, v[20:23] offset:2048
  ds_write_b128 v4, v[24:27] offset:2064
  ds_read_b128 v[28:31], v13 offset:2048
  ds_read_b128 v[32:35], v13 offset:3072
  s_waitcnt lgkmcnt(4)
  buffer_store_dwordx4 v[172:175], v6, s[12:15], s37 offen sc1
  buffer_store_dwordx4 v[176:179], v6, s[12:15], s38 offen sc1
  s_and_b32 s41, s39, 255
  s_cmp_eq_u32 s41, 0
  s_waitcnt lgkmcnt(0)
  s_cbranch_scc1 k23_kernel_noim
  buffer_store_dwordx4 v[28:31], v6, s[12:15], s37 offen offset:128 sc1
  buffer_store_dwordx4 v[32:35], v6, s[12:15], s38 offen offset:128 sc1
k23_kernel_noim:
  s_branch k23_kernel_zpart
k23_kernel_nojob:
k23_kernel_zpart:
  s_sub_u32 s41, s36, 4
  s_and_b32 s37, s2, 7
  s_lshl_b32 s37, s37, 2
  s_bfe_u32 s44, s2, 0x20003
  s_add_u32 s37, s37, s44
  s_lshr_b32 s38, s2, 5
  s_and_b32 s39, s41, 1
  s_lshr_b32 s40, s41, 1
  v_and_b32 v2, 31, v1
  v_lshrrev_b32 v3, 5, v1
  v_lshlrev_b32 v12, 4, v1
  v_lshlrev_b32 v14, 16, v2
  v_lshl_add_u32 v14, v3, 5, v14
  s_lshl_b32 s42, s37, 11
  s_lshl_b32 s43, s39, 10
  s_add_u32 s42, s42, s43
  s_lshl_b32 s43, s38, 7
  s_add_u32 s42, s42, s43
  s_lshl_b32 s43, s40, 6
  s_add_u32 s42, s42, s43
  v_add_u32 v14, s42, v14
  buffer_load_dwordx4 v[24:27], v14, s[4:7], 0 offen
  buffer_load_dwordx4 v[28:31], v14, s[4:7], 0 offen offset:16
  s_setprio 0
  v_lshrrev_b32 v4, 3, v1
  v_bfe_u32 v5, v1, 4, 1
  v_lshlrev_b32 v5, 2, v5
  v_and_b32 v6, 7, v1
  v_xor_b32 v5, v5, v6
  v_lshlrev_b32 v5, 4, v5
  v_lshl_add_u32 v13, v4, 7, v5
  s_lshl_b32 s46, s41, 14
  s_add_u32 s46, s46, 0
  s_lshl_b32 s45, s41, 14
  s_lshl_b32 s43, s37, 16
  s_add_u32 s45, s45, s43
  s_add_u32 s45, s45, 13631488
  v_bfe_u32 v4, v1, 2, 2
  v_and_b32 v5, 3, v1
  v_bfe_u32 v6, v1, 4, 1
  v_lshl_add_u32 v7, v3, 2, v4
  v_lshlrev_b32 v7, 7, v7
  v_lshrrev_b32 v4, 1, v4
  v_xor_b32 v8, s39, v4
  v_lshl_add_u32 v8, v8, 6, v7
  v_add_u32 v8, s46, v8
  v_lshl_add_u32 v8, v6, 5, v8
  v_lshl_add_u32 v18, v5, 3, v8
  v_xor_b32 v19, 64, v18
  v_bfe_u32 v4, v2, 2, 1
  v_lshlrev_b32 v4, 4, v4
  v_lshrrev_b32 v5, 3, v2
  v_lshl_add_u32 v4, v5, 2, v4
  v_and_b32 v5, 3, v2
  v_add_u32 v4, v4, v5
  s_lshl_b32 s43, s38, 6
  s_lshl_b32 s44, s40, 5
  s_add_u32 s43, s43, s44
  v_add_u32 v4, s43, v4
  v_lshlrev_b32 v15, 31, v4
  v_or_b32 v15, 0x3f803f80, v15
  v_xor_b32 v6, 32, v4
  v_cvt_f32_u32 v20, v4
  v_cvt_f32_u32 v21, v6
  v_mul_f32 v20, 0x3b000000, v20
  v_mul_f32 v21, 0x3b000000, v21
  s_lshl_b32 s43, s41, 6
  v_lshl_add_u32 v5, v3, 1, s43
  v_cvt_f32_u32 v6, v5
  v_mul_f32 v22, v6, v20
  v_fract_f32 v22, v22
  v_mul_f32 v23, v6, v21
  v_fract_f32 v23, v23
  v_cmp_eq_u32 s[48:49], 0, v5
  v_fmamk_f32 v4, v20, 0x00000000, v22
  v_cos_f32 v5, v4
  v_sin_f32 v6, v4
  v_fmamk_f32 v7, v20, 0x3f800000, v22
  v_cvt_pk_bf16_f32 v164, v5, -v6
  v_cos_f32 v8, v7
  v_sin_f32 v9, v7
  v_fmamk_f32 v4, v20, 0x40800000, v22
  v_cvt_pk_bf16_f32 v165, v8, -v9
  v_cos_f32 v5, v4
  v_sin_f32 v6, v4
  v_fmamk_f32 v7, v20, 0x40a00000, v22
  v_cvt_pk_bf16_f32 v166, v5, -v6
  v_cos_f32 v8, v7
  v_sin_f32 v9, v7
  v_fmamk_f32 v4, v21, 0x00000000, v23
  v_cvt_pk_bf16_f32 v167, v8, -v9
  v_cos_f32 v5, v4
  v_sin_f32 v6, v4
  v_fmamk_f32 v7, v21, 0x3f800000, v23
  v_cvt_pk_bf16_f32 v168, v5, -v6
  v_cos_f32 v8, v7
  v_sin_f32 v9, v7
  v_fmamk_f32 v4, v21, 0x40800000, v23
  v_cvt_pk_bf16_f32 v169, v8, -v9
  v_cos_f32 v5, v4
  v_sin_f32 v6, v4
  v_fmamk_f32 v7, v21, 0x40a00000, v23
  v_cvt_pk_bf16_f32 v170, v5, -v6
  v_cos_f32 v8, v7
  v_sin_f32 v9, v7
  v_fmamk_f32 v4, v20, 0x41000000, v22
  v_cvt_pk_bf16_f32 v171, v8, -v9
  v_cos_f32 v5, v4
  v_sin_f32 v6, v4
  v_fmamk_f32 v7, v20, 0x41100000, v22
  v_cvt_pk_bf16_f32 v172, v5, -v6
  v_cos_f32 v8, v7
  v_sin_f32 v9, v7
  v_fmamk_f32 v4, v20, 0x41400000, v22
  v_cvt_pk_bf16_f32 v173, v8, -v9
  v_cos_f32 v5, v4
  v_sin_f32 v6, v4
  v_fmamk_f32 v7, v20, 0x41500000, v22
  v_cvt_pk_bf16_f32 v174, v5, -v6
  v_cos_f32 v8, v7
  v_sin_f32 v9, v7
  v_fmamk_f32 v4, v21, 0x41000000, v23
  v_cvt_pk_bf16_f32 v175, v8, -v9
  v_cos_f32 v5, v4
  v_sin_f32 v6, v4
  v_fmamk_f32 v7, v21, 0x41100000, v23
  v_cvt_pk_bf16_f32 v176, v5, -v6
  v_cos_f32 v8, v7
  v_sin_f32 v9, v7
  v_fmamk_f32 v4, v21, 0x41400000, v23
  v_cvt_pk_bf16_f32 v177, v8, -v9
  v_cos_f32 v5, v4
  v_sin_f32 v6, v4
  v_fmamk_f32 v7, v21, 0x41500000, v23
  v_cvt_pk_bf16_f32 v178, v5, -v6
  v_cos_f32 v8, v7
  v_sin_f32 v9, v7
  v_fmamk_f32 v4, v20, 0x41800000, v22
  v_cvt_pk_bf16_f32 v179, v8, -v9
  v_cos_f32 v5, v4
  v_sin_f32 v6, v4
  v_fmamk_f32 v7, v20, 0x41880000, v22
  v_cvt_pk_bf16_f32 v180, v5, -v6
  v_cos_f32 v8, v7
  v_sin_f32 v9, v7
  v_fmamk_f32 v4, v20, 0x41a00000, v22
  v_cvt_pk_bf16_f32 v181, v8, -v9
  v_cos_f32 v5, v4
  v_sin_f32 v6, v4
  v_fmamk_f32 v7, v20, 0x41a80000, v22
  v_cvt_pk_bf16_f32 v182, v5, -v6
  v_cos_f32 v8, v7
  v_sin_f32 v9, v7
  v_fmamk_f32 v4, v21, 0x41800000, v23
  v_cvt_pk_bf16_f32 v183, v8, -v9
  v_cos_f32 v5, v4
  v_sin_f32 v6, v4
  v_fmamk_f32 v7, v21, 0x41880000, v23
  v_cvt_pk_bf16_f32 v184, v5, -v6
  v_cos_f32 v8, v7
  v_sin_f32 v9, v7
  v_fmamk_f32 v4, v21, 0x41a00000, v23
  v_cvt_pk_bf16_f32 v185, v8, -v9
  v_cos_f32 v5, v4
  v_sin_f32 v6, v4
  v_fmamk_f32 v7, v21, 0x41a80000, v23
  v_cvt_pk_bf16_f32 v186, v5, -v6
  v_cos_f32 v8, v7
  v_sin_f32 v9, v7
  v_fmamk_f32 v4, v20, 0x41c00000, v22
  v_cvt_pk_bf16_f32 v187, v8, -v9
  v_cos_f32 v5, v4
  v_sin_f32 v6, v4
  v_fmamk_f32 v7, v20, 0x41c80000, v22
  v_cvt_pk_bf16_f32 v188, v5, -v6
  v_cos_f32 v8, v7
  v_sin_f32 v9, v7
  v_fmamk_f32 v4, v20, 0x41e00000, v22
  v_cvt_pk_bf16_f32 v189, v8, -v9
  v_cos_f32 v5, v4
  v_sin_f32 v6, v4
  v_fmamk_f32 v7, v20, 0x41e80000, v22
  v_cvt_pk_bf16_f32 v190, v5, -v6
  v_cos_f32 v8, v7
  v_sin_f32 v9, v7
  v_fmamk_f32 v4, v21, 0x41c00000, v23
  v_cvt_pk_bf16_f32 v191, v8, -v9
  v_cos_f32 v5, v4
  v_sin_f32 v6, v4
  v_fmamk_f32 v7, v21, 0x41c80000, v23
  v_cvt_pk_bf16_f32 v192, v5, -v6
  v_cos_f32 v8, v7
  v_sin_f32 v9, v7
  v_fmamk_f32 v4, v21, 0x41e00000, v23
  v_cvt_pk_bf16_f32 v193, v8, -v9
  v_cos_f32 v5, v4
  v_sin_f32 v6, v4
  v_fmamk_f32 v7, v21, 0x41e80000, v23
  v_cvt_pk_bf16_f32 v194, v5, -v6
  v_cos_f32 v8, v7
  v_sin_f32 v9, v7
  v_fmamk_f32 v4, v20, 0x42000000, v22
  v_cvt_pk_bf16_f32 v195, v8, -v9
  v_cos_f32 v5, v4
  v_sin_f32 v6, v4
  v_fmamk_f32 v7, v20, 0x42040000, v22
  v_cvt_pk_bf16_f32 v196, v5, -v6
  v_cos_f32 v8, v7
  v_sin_f32 v9, v7
  v_fmamk_f32 v4, v20, 0x42100000, v22
  v_cvt_pk_bf16_f32 v197, v8, -v9
  v_cos_f32 v5, v4
  v_sin_f32 v6, v4
  v_fmamk_f32 v7, v20, 0x42140000, v22
  v_cvt_pk_bf16_f32 v198, v5, -v6
  v_cos_f32 v8, v7
  v_sin_f32 v9, v7
  v_fmamk_f32 v4, v21, 0x42000000, v23
  v_cvt_pk_bf16_f32 v199, v8, -v9
  v_cos_f32 v5, v4
  v_sin_f32 v6, v4
  v_fmamk_f32 v7, v21, 0x42040000, v23
  v_cvt_pk_bf16_f32 v200, v5, -v6
  v_cos_f32 v8, v7
  v_sin_f32 v9, v7
  v_fmamk_f32 v4, v21, 0x42100000, v23
  v_cvt_pk_bf16_f32 v201, v8, -v9
  v_cos_f32 v5, v4
  v_sin_f32 v6, v4
  v_fmamk_f32 v7, v21, 0x42140000, v23
  v_cvt_pk_bf16_f32 v202, v5, -v6
  v_cos_f32 v8, v7
  v_sin_f32 v9, v7
  v_fmamk_f32 v4, v20, 0x42200000, v22
  v_cvt_pk_bf16_f32 v203, v8, -v9
  v_cos_f32 v5, v4
  v_sin_f32 v6, v4
  v_fmamk_f32 v7, v20, 0x42240000, v22
  v_cvt_pk_bf16_f32 v204, v5, -v6
  v_cos_f32 v8, v7
  v_sin_f32 v9, v7
  v_fmamk_f32 v4, v20, 0x42300000, v22
  v_cvt_pk_bf16_f32 v205, v8, -v9
  v_cos_f32 v5, v4
  v_sin_f32 v6, v4
  v_fmamk_f32 v7, v20, 0x42340000, v22
  v_cvt_pk_bf16_f32 v206, v5, -v6
  v_cos_f32 v8, v7
  v_sin_f32 v9, v7
  v_fmamk_f32 v4, v21, 0x42200000, v23
  v_cvt_pk_bf16_f32 v207, v8, -v9
  v_cos_f32 v5, v4
  v_sin_f32 v6, v4
  v_fmamk_f32 v7, v21, 0x42240000, v23
  v_cvt_pk_bf16_f32 v208, v5, -v6
  v_cos_f32 v8, v7
  v_sin_f32 v9, v7
  v_fmamk_f32 v4, v21, 0x42300000, v23
  v_cvt_pk_bf16_f32 v209, v8, -v9
  v_cos_f32 v5, v4
  v_sin_f32 v6, v4
  v_fmamk_f32 v7, v21, 0x42340000, v23
  v_cvt_pk_bf16_f32 v210, v5, -v6
  v_cos_f32 v8, v7
  v_sin_f32 v9, v7
  v_fmamk_f32 v4, v20, 0x42400000, v22
  v_cvt_pk_bf16_f32 v211, v8, -v9
  v_cos_f32 v5, v4
  v_sin_f32 v6, v4
  v_fmamk_f32 v7, v20, 0x42440000, v22
  v_cvt_pk_bf16_f32 v212, v5, -v6
  v_cos_f32 v8, v7
  v_sin_f32 v9, v7
  v_fmamk_f32 v4, v20, 0x42500000, v22
  v_cvt_pk_bf16_f32 v213, v8, -v9
  v_cos_f32 v5, v4
  v_sin_f32 v6, v4
  v_fmamk_f32 v7, v20, 0x42540000, v22
  v_cvt_pk_bf16_f32 v214, v5, -v6
  v_cos_f32 v8, v7
  v_sin_f32 v9, v7
  v_fmamk_f32 v4, v21, 0x42400000, v23
  v_cvt_pk_bf16_f32 v215, v8, -v9
  v_cos_f32 v5, v4
  v_sin_f32 v6, v4
  v_fmamk_f32 v7, v21, 0x42440000, v23
  v_cvt_pk_bf16_f32 v216, v5, -v6
  v_cos_f32 v8, v7
  v_sin_f32 v9, v7
  v_fmamk_f32 v4, v21, 0x42500000, v23
  v_cvt_pk_bf16_f32 v217, v8, -v9
  v_cos_f32 v5, v4
  v_sin_f32 v6, v4
  v_fmamk_f32 v7, v21, 0x42540000, v23
  v_cvt_pk_bf16_f32 v218, v5, -v6
  v_cos_f32 v8, v7
  v_sin_f32 v9, v7
  v_fmamk_f32 v4, v20, 0x42600000, v22
  v_cvt_pk_bf16_f32 v219, v8, -v9
  v_cos_f32 v5, v4
  v_sin_f32 v6, v4
  v_fmamk_f32 v7, v20, 0x42640000, v22
  v_cvt_pk_bf16_f32 v220, v5, -v6
  v_cos_f32 v8, v7
  v_sin_f32 v9, v7
  v_fmamk_f32 v4, v20, 0x42700000, v22
  v_cvt_pk_bf16_f32 v221, v8, -v9
  v_cos_f32 v5, v4
  v_sin_f32 v6, v4
  v_fmamk_f32 v7, v20, 0x42740000, v22
  v_cvt_pk_bf16_f32 v222, v5, -v6
  v_cos_f32 v8, v7
  v_sin_f32 v9, v7
  v_fmamk_f32 v4, v21, 0x42600000, v23
  v_cvt_pk_bf16_f32 v223, v8, -v9
  v_cos_f32 v5, v4
  v_sin_f32 v6, v4
  v_fmamk_f32 v7, v21, 0x42640000, v23
  v_cvt_pk_bf16_f32 v224, v5, -v6
  v_cos_f32 v8, v7
  v_sin_f32 v9, v7
  v_fmamk_f32 v4, v21, 0x42700000, v23
  v_cvt_pk_bf16_f32 v225, v8, -v9
  v_cos_f32 v5, v4
  v_sin_f32 v6, v4
  v_fmamk_f32 v7, v21, 0x42740000, v23
  v_cvt_pk_bf16_f32 v226, v5, -v6
  v_cos_f32 v8, v7
  v_sin_f32 v9, v7
  v_cndmask_b32 v164, v164, v15, s[48:49]
  v_cvt_pk_bf16_f32 v227, v8, -v9
  v_cndmask_b32 v168, v168, v15, s[48:49]
  s_waitcnt vmcnt(0)
  v_lshlrev_b32 v36, 16, v24
  v_and_b32 v37, 0xffff0000, v24
  v_lshlrev_b32 v38, 16, v25
  v_and_b32 v39, 0xffff0000, v25
  v_lshlrev_b32 v40, 16, v26
  v_and_b32 v41, 0xffff0000, v26
  v_lshlrev_b32 v42, 16, v27
  v_and_b32 v43, 0xffff0000, v27
  v_lshlrev_b32 v44, 16, v28
  v_and_b32 v45, 0xffff0000, v28
  v_lshlrev_b32 v46, 16, v29
  v_and_b32 v47, 0xffff0000, v29
  v_lshlrev_b32 v48, 16, v30
  v_and_b32 v49, 0xffff0000, v30
  v_lshlrev_b32 v50, 16, v31
  v_and_b32 v51, 0xffff0000, v31
  v_add_u32 v4, s46, v12
  s_xor_b32 s42, s41, 1
  s_lshl_b32 s42, s42, 14
  s_add_u32 s42, s42, 0
  v_add_u32 v5, s42, v12
  s_xor_b32 s42, s41, 2
  s_lshl_b32 s42, s42, 14
  s_add_u32 s42, s42, 4096
  v_add_u32 v6, s42, v12
  s_xor_b32 s42, s41, 3
  s_lshl_b32 s42, s42, 14
  s_add_u32 s42, s42, 8192
  v_add_u32 v7, s42, v12
  v_and_b32 v16, 3, v1
  v_lshlrev_b32 v16, 4, v16
  v_add_u32 v16, 122888, v16
  s_lshl_b32 s43, s41, 4
  s_add_u32 s43, s43, 122888
  v_mov_b32 v8, s43
  v_mov_b32 v17, 1
  v_mov_b32 v10, 122892
  s_cmp_lg_u32 s41, 0
  s_cbranch_scc1 k23_kernel_lw
  ds_write_b32 v10, v17
k23_kernel_lw:
  ds_read_b32 v9, v10
  s_waitcnt lgkmcnt(0)
  v_readfirstlane_b32 s42, v9
  s_cmp_lg_u32 s42, 0
  s_cbranch_scc1 k23_kernel_lwok
  s_sleep 2
  s_branch k23_kernel_lw
k23_kernel_lwok:
  s_mov_b32 s47, 16384
  s_mov_b32 s43, 0xffff
  s_setprio 1
  s_add_u32 m0, s46, 0
  s_add_u32 s44, s45, 0
  buffer_load_dwordx4 v13, s[12:15], s44 offen sc1 lds
  s_add_u32 m0, s46, 1024
  s_add_u32 s44, s45, 1024
  buffer_load_dwordx4 v13, s[12:15], s44 offen sc1 lds
  s_add_u32 m0, s46, 2048
  s_add_u32 s44, s45, 2048
  buffer_load_dwordx4 v13, s[12:15], s44 offen sc1 lds
  s_add_u32 m0, s46, 3072
  s_add_u32 s44, s45, 3072
  buffer_load_dwordx4 v13, s[12:15], s44 offen sc1 lds
  s_add_u32 m0, s46, 4096
  s_add_u32 s44, s45, 4096
  buffer_load_dwordx4 v13, s[12:15], s44 offen sc1 lds
  s_add_u32 m0, s46, 5120
  s_add_u32 s44, s45, 5120
  buffer_load_dwordx4 v13, s[12:15], s44 offen sc1 lds
  s_add_u32 m0, s46, 6144
  s_add_u32 s44, s45, 6144
  buffer_load_dwordx4 v13, s[12:15], s44 offen sc1 lds
  s_add_u32 m0, s46, 7168
  s_add_u32 s44, s45, 7168
  buffer_load_dwordx4 v13, s[12:15], s44 offen sc1 lds
  s_add_u32 m0, s46, 8192
  s_add_u32 s44, s45, 8192
  buffer_load_dwordx4 v13, s[12:15], s44 offen sc1 lds
  s_add_u32 m0, s46, 9216
  s_add_u32 s44, s45, 9216
  buffer_load_dwordx4 v13, s[12:15], s44 offen sc1 lds
  s_add_u32 m0, s46, 10240
  s_add_u32 s44, s45, 10240
  buffer_load_dwordx4 v13, s[12:15], s44 offen sc1 lds
  s_add_u32 m0, s46, 11264
  s_add_u32 s44, s45, 11264
  buffer_load_dwordx4 v13, s[12:15], s44 offen sc1 lds
  s_add_u32 m0, s46, 12288
  s_add_u32 s44, s45, 12288
  buffer_load_dwordx4 v13, s[12:15], s44 offen sc1 lds
  s_add_u32 m0, s46, 13312
  s_add_u32 s44, s45, 13312
  buffer_load_dwordx4 v13, s[12:15], s44 offen sc1 lds
  s_add_u32 m0, s46, 14336
  s_add_u32 s44, s45, 14336
  buffer_load_dwordx4 v13, s[12:15], s44 offen sc1 lds
  s_add_u32 m0, s46, 15360
  s_add_u32 s44, s45, 15360
  buffer_load_dwordx4 v13, s[12:15], s44 offen sc1 lds
  s_waitcnt vmcnt(14)
  ds_read_b64_tr_b16 v[100:101], v19 offset:0
  ds_read_b64_tr_b16 v[102:103], v19 offset:1024
  ds_read_b64_tr_b16 v[132:133], v18 offset:0
  ds_read_b64_tr_b16 v[134:135], v18 offset:1024
  s_waitcnt vmcnt(12)
  ds_read_b64_tr_b16 v[104:105], v19 offset:2048
  ds_read_b64_tr_b16 v[106:107], v19 offset:3072
  ds_read_b64_tr_b16 v[136:137], v18 offset:2048
  ds_read_b64_tr_b16 v[138:139], v18 offset:3072
  s_waitcnt lgkmcnt(4)
k23_kernel_zc0:
  v_pk_max_u16 v9, v100, v101
  v_pk_max_u16 v10, v102, v103
  v_pk_max_u16 v9, v9, v132
  v_pk_max_u16 v10, v10, v133
  v_pk_max_u16 v9, v9, v134
  v_pk_max_u16 v10, v10, v135
  v_pk_max_u16 v9, v9, v10
  v_lshrrev_b32 v10, 16, v9
  v_max_u16 v9, v9, v10
  v_and_b32 v9, 0xffff, v9
  v_cmp_eq_u32 vcc, s43, v9
  s_cmp_eq_u32 s47, 0
  s_cbranch_scc1 k23_kernel_zo0
  s_nop 2
  s_cbranch_vccz k23_kernel_zo0
  s_sub_u32 s47, s47, 1
  s_sleep 4
  s_add_u32 m0, s46, 0
  s_add_u32 s44, s45, 0
  buffer_load_dwordx4 v13, s[12:15], s44 offen sc1 lds
  s_add_u32 m0, s46, 1024
  s_add_u32 s44, s45, 1024
  buffer_load_dwordx4 v13, s[12:15], s44 offen sc1 lds
  s_waitcnt vmcnt(0)
  ds_read_b64_tr_b16 v[100:101], v19 offset:0
  ds_read_b64_tr_b16 v[102:103], v19 offset:1024
  ds_read_b64_tr_b16 v[132:133], v18 offset:0
  ds_read_b64_tr_b16 v[134:135], v18 offset:1024
  s_waitcnt lgkmcnt(0)
  s_branch k23_kernel_zc0
k23_kernel_zo0:
  v_mfma_f32_32x32x16_bf16 v[84:99], v[168:171], v[100:103], 0
  v_mfma_f32_32x32x16_bf16 v[52:67], v[164:167], v[100:103], 0
  v_mfma_f32_32x32x16_bf16 v[68:83], v[168:171], v[132:135], 0
  s_waitcnt vmcnt(10)
  ds_read_b64_tr_b16 v[108:109], v19 offset:4096
  ds_read_b64_tr_b16 v[110:111], v19 offset:5120
  ds_read_b64_tr_b16 v[140:141], v18 offset:4096
  ds_read_b64_tr_b16 v[142:143], v18 offset:5120
  s_waitcnt lgkmcnt(4)
k23_kernel_zc1:
  v_pk_max_u16 v9, v104, v105
  v_pk_max_u16 v10, v106, v107
  v_pk_max_u16 v9, v9, v136
  v_pk_max_u16 v10, v10, v137
  v_pk_max_u16 v9, v9, v138
  v_pk_max_u16 v10, v10, v139
  v_pk_max_u16 v9, v9, v10
  v_lshrrev_b32 v10, 16, v9
  v_max_u16 v9, v9, v10
  v_and_b32 v9, 0xffff, v9
  v_cmp_eq_u32 vcc, s43, v9
  s_cmp_eq_u32 s47, 0
  s_cbranch_scc1 k23_kernel_zo1
  s_nop 2
  s_cbranch_vccz k23_kernel_zo1
  s_sub_u32 s47, s47, 1
  s_sleep 4
  s_add_u32 m0, s46, 2048
  s_add_u32 s44, s45, 2048
  buffer_load_dwordx4 v13, s[12:15], s44 offen sc1 lds
  s_add_u32 m0, s46, 3072
  s_add_u32 s44, s45, 3072
  buffer_load_dwordx4 v13, s[12:15], s44 offen sc1 lds
  s_waitcnt vmcnt(0)
  ds_read_b64_tr_b16 v[104:105], v19 offset:2048
  ds_read_b64_tr_b16 v[106:107], v19 offset:3072
  ds_read_b64_tr_b16 v[136:137], v18 offset:2048
  ds_read_b64_tr_b16 v[138:139], v18 offset:3072
  s_waitcnt lgkmcnt(0)
  s_branch k23_kernel_zc1
k23_kernel_zo1:
  v_mfma_f32_32x32x16_bf16 v[84:99], v[176:179], v[104:107], v[84:99]
  v_mfma_f32_32x32x16_bf16 v[52:67], v[172:175], v[104:107], v[52:67]
  v_mfma_f32_32x32x16_bf16 v[68:83], v[176:179], v[136:139], v[68:83]
  s_waitcnt vmcnt(8)
  ds_read_b64_tr_b16 v[112:113], v19 offset:6144
  ds_read_b64_tr_b16 v[114:115], v19 offset:7168
  ds_read_b64_tr_b16 v[144:145], v18 offset:6144
  ds_read_b64_tr_b16 v[146:147], v18 offset:7168
  s_waitcnt lgkmcnt(4)
k23_kernel_zc2:
  v_pk_max_u16 v9, v108, v109
  v_pk_max_u16 v10, v110, v111
  v_pk_max_u16 v9, v9, v140
  v_pk_max_u16 v10, v10, v141
  v_pk_max_u16 v9, v9, v142
  v_pk_max_u16 v10, v10, v143
  v_pk_max_u16 v9, v9, v10
  v_lshrrev_b32 v10, 16, v9
  v_max_u16 v9, v9, v10
  v_and_b32 v9, 0xffff, v9
  v_cmp_eq_u32 vcc, s43, v9
  s_cmp_eq_u32 s47, 0
  s_cbranch_scc1 k23_kernel_zo2
  s_nop 2
  s_cbranch_vccz k23_kernel_zo2
  s_sub_u32 s47, s47, 1
  s_sleep 4
  s_add_u32 m0, s46, 4096
  s_add_u32 s44, s45, 4096
  buffer_load_dwordx4 v13, s[12:15], s44 offen sc1 lds
  s_add_u32 m0, s46, 5120
  s_add_u32 s44, s45, 5120
  buffer_load_dwordx4 v13, s[12:15], s44 offen sc1 lds
  s_waitcnt vmcnt(0)
  ds_read_b64_tr_b16 v[108:109], v19 offset:4096
  ds_read_b64_tr_b16 v[110:111], v19 offset:5120
  ds_read_b64_tr_b16 v[140:141], v18 offset:4096
  ds_read_b64_tr_b16 v[142:143], v18 offset:5120
  s_waitcnt lgkmcnt(0)
  s_branch k23_kernel_zc2
k23_kernel_zo2:
  v_mfma_f32_32x32x16_bf16 v[84:99], v[184:187], v[108:111], v[84:99]
  v_mfma_f32_32x32x16_bf16 v[52:67], v[180:183], v[108:111], v[52:67]
  v_mfma_f32_32x32x16_bf16 v[68:83], v[184:187], v[140:143], v[68:83]
  s_waitcnt vmcnt(6)
  ds_read_b64_tr_b16 v[116:117], v19 offset:8192
  ds_read_b64_tr_b16 v[118:119], v19 offset:9216
  ds_read_b64_tr_b16 v[148:149], v18 offset:8192
  ds_read_b64_tr_b16 v[150:151], v18 offset:9216
  s_waitcnt lgkmcnt(4)
k23_kernel_zc3:
  v_pk_max_u16 v9, v112, v113
  v_pk_max_u16 v10, v114, v115
  v_pk_max_u16 v9, v9, v144
  v_pk_max_u16 v10, v10, v145
  v_pk_max_u16 v9, v9, v146
  v_pk_max_u16 v10, v10, v147
  v_pk_max_u16 v9, v9, v10
  v_lshrrev_b32 v10, 16, v9
  v_max_u16 v9, v9, v10
  v_and_b32 v9, 0xffff, v9
  v_cmp_eq_u32 vcc, s43, v9
  s_cmp_eq_u32 s47, 0
  s_cbranch_scc1 k23_kernel_zo3
  s_nop 2
  s_cbranch_vccz k23_kernel_zo3
  s_sub_u32 s47, s47, 1
  s_sleep 4
  s_add_u32 m0, s46, 6144
  s_add_u32 s44, s45, 6144
  buffer_load_dwordx4 v13, s[12:15], s44 offen sc1 lds
  s_add_u32 m0, s46, 7168
  s_add_u32 s44, s45, 7168
  buffer_load_dwordx4 v13, s[12:15], s44 offen sc1 lds
  s_waitcnt vmcnt(0)
  ds_read_b64_tr_b16 v[112:113], v19 offset:6144
  ds_read_b64_tr_b16 v[114:115], v19 offset:7168
  ds_read_b64_tr_b16 v[144:145], v18 offset:6144
  ds_read_b64_tr_b16 v[146:147], v18 offset:7168
  s_waitcnt lgkmcnt(0)
  s_branch k23_kernel_zc3
k23_kernel_zo3:
  v_mfma_f32_32x32x16_bf16 v[84:99], v[192:195], v[112:115], v[84:99]
  v_mfma_f32_32x32x16_bf16 v[52:67], v[188:191], v[112:115], v[52:67]
  v_mfma_f32_32x32x16_bf16 v[68:83], v[192:195], v[144:147], v[68:83]
  s_waitcnt vmcnt(4)
  ds_read_b64_tr_b16 v[120:121], v19 offset:10240
  ds_read_b64_tr_b16 v[122:123], v19 offset:11264
  ds_read_b64_tr_b16 v[152:153], v18 offset:10240
  ds_read_b64_tr_b16 v[154:155], v18 offset:11264
  s_waitcnt lgkmcnt(4)
k23_kernel_zc4:
  v_pk_max_u16 v9, v116, v117
  v_pk_max_u16 v10, v118, v119
  v_pk_max_u16 v9, v9, v148
  v_pk_max_u16 v10, v10, v149
  v_pk_max_u16 v9, v9, v150
  v_pk_max_u16 v10, v10, v151
  v_pk_max_u16 v9, v9, v10
  v_lshrrev_b32 v10, 16, v9
  v_max_u16 v9, v9, v10
  v_and_b32 v9, 0xffff, v9
  v_cmp_eq_u32 vcc, s43, v9
  s_cmp_eq_u32 s47, 0
  s_cbranch_scc1 k23_kernel_zo4
  s_nop 2
  s_cbranch_vccz k23_kernel_zo4
  s_sub_u32 s47, s47, 1
  s_sleep 4
  s_add_u32 m0, s46, 8192
  s_add_u32 s44, s45, 8192
  buffer_load_dwordx4 v13, s[12:15], s44 offen sc1 lds
  s_add_u32 m0, s46, 9216
  s_add_u32 s44, s45, 9216
  buffer_load_dwordx4 v13, s[12:15], s44 offen sc1 lds
  s_waitcnt vmcnt(0)
  ds_read_b64_tr_b16 v[116:117], v19 offset:8192
  ds_read_b64_tr_b16 v[118:119], v19 offset:9216
  ds_read_b64_tr_b16 v[148:149], v18 offset:8192
  ds_read_b64_tr_b16 v[150:151], v18 offset:9216
  s_waitcnt lgkmcnt(0)
  s_branch k23_kernel_zc4
k23_kernel_zo4:
  v_mfma_f32_32x32x16_bf16 v[84:99], v[200:203], v[116:119], v[84:99]
  v_mfma_f32_32x32x16_bf16 v[52:67], v[196:199], v[116:119], v[52:67]
  v_mfma_f32_32x32x16_bf16 v[68:83], v[200:203], v[148:151], v[68:83]
  s_waitcnt vmcnt(2)
  ds_read_b64_tr_b16 v[124:125], v19 offset:12288
  ds_read_b64_tr_b16 v[126:127], v19 offset:13312
  ds_read_b64_tr_b16 v[156:157], v18 offset:12288
  ds_read_b64_tr_b16 v[158:159], v18 offset:13312
  s_waitcnt lgkmcnt(4)
k23_kernel_zc5:
  v_pk_max_u16 v9, v120, v121
  v_pk_max_u16 v10, v122, v123
  v_pk_max_u16 v9, v9, v152
  v_pk_max_u16 v10, v10, v153
  v_pk_max_u16 v9, v9, v154
  v_pk_max_u16 v10, v10, v155
  v_pk_max_u16 v9, v9, v10
  v_lshrrev_b32 v10, 16, v9
  v_max_u16 v9, v9, v10
  v_and_b32 v9, 0xffff, v9
  v_cmp_eq_u32 vcc, s43, v9
  s_cmp_eq_u32 s47, 0
  s_cbranch_scc1 k23_kernel_zo5
  s_nop 2
  s_cbranch_vccz k23_kernel_zo5
  s_sub_u32 s47, s47, 1
  s_sleep 4
  s_add_u32 m0, s46, 10240
  s_add_u32 s44, s45, 10240
  buffer_load_dwordx4 v13, s[12:15], s44 offen sc1 lds
  s_add_u32 m0, s46, 11264
  s_add_u32 s44, s45, 11264
  buffer_load_dwordx4 v13, s[12:15], s44 offen sc1 lds
  s_waitcnt vmcnt(0)
  ds_read_b64_tr_b16 v[120:121], v19 offset:10240
  ds_read_b64_tr_b16 v[122:123], v19 offset:11264
  ds_read_b64_tr_b16 v[152:153], v18 offset:10240
  ds_read_b64_tr_b16 v[154:155], v18 offset:11264
  s_waitcnt lgkmcnt(0)
  s_branch k23_kernel_zc5
k23_kernel_zo5:
  v_mfma_f32_32x32x16_bf16 v[84:99], v[208:211], v[120:123], v[84:99]
  v_mfma_f32_32x32x16_bf16 v[52:67], v[204:207], v[120:123], v[52:67]
  v_mfma_f32_32x32x16_bf16 v[68:83], v[208:211], v[152:155], v[68:83]
  s_waitcnt vmcnt(0)
  ds_read_b64_tr_b16 v[128:129], v19 offset:14336
  ds_read_b64_tr_b16 v[130:131], v19 offset:15360
  ds_read_b64_tr_b16 v[160:161], v18 offset:14336
  ds_read_b64_tr_b16 v[162:163], v18 offset:15360
  s_waitcnt lgkmcnt(4)
k23_kernel_zc6:
  v_pk_max_u16 v9, v124, v125
  v_pk_max_u16 v10, v126, v127
  v_pk_max_u16 v9, v9, v156
  v_pk_max_u16 v10, v10, v157
  v_pk_max_u16 v9, v9, v158
  v_pk_max_u16 v10, v10, v159
  v_pk_max_u16 v9, v9, v10
  v_lshrrev_b32 v10, 16, v9
  v_max_u16 v9, v9, v10
  v_and_b32 v9, 0xffff, v9
  v_cmp_eq_u32 vcc, s43, v9
  s_cmp_eq_u32 s47, 0
  s_cbranch_scc1 k23_kernel_zo6
  s_nop 2
  s_cbranch_vccz k23_kernel_zo6
  s_sub_u32 s47, s47, 1
  s_sleep 4
  s_add_u32 m0, s46, 12288
  s_add_u32 s44, s45, 12288
  buffer_load_dwordx4 v13, s[12:15], s44 offen sc1 lds
  s_add_u32 m0, s46, 13312
  s_add_u32 s44, s45, 13312
  buffer_load_dwordx4 v13, s[12:15], s44 offen sc1 lds
  s_waitcnt vmcnt(0)
  ds_read_b64_tr_b16 v[124:125], v19 offset:12288
  ds_read_b64_tr_b16 v[126:127], v19 offset:13312
  ds_read_b64_tr_b16 v[156:157], v18 offset:12288
  ds_read_b64_tr_b16 v[158:159], v18 offset:13312
  s_waitcnt lgkmcnt(0)
  s_branch k23_kernel_zc6
k23_kernel_zo6:
  v_mfma_f32_32x32x16_bf16 v[84:99], v[216:219], v[124:127], v[84:99]
  v_mfma_f32_32x32x16_bf16 v[52:67], v[212:215], v[124:127], v[52:67]
  v_mfma_f32_32x32x16_bf16 v[68:83], v[216:219], v[156:159], v[68:83]
  s_waitcnt lgkmcnt(0)
k23_kernel_zc7:
  v_pk_max_u16 v9, v128, v129
  v_pk_max_u16 v10, v130, v131
  v_pk_max_u16 v9, v9, v160
  v_pk_max_u16 v10, v10, v161
  v_pk_max_u16 v9, v9, v162
  v_pk_max_u16 v10, v10, v163
  v_pk_max_u16 v9, v9, v10
  v_lshrrev_b32 v10, 16, v9
  v_max_u16 v9, v9, v10
  v_and_b32 v9, 0xffff, v9
  v_cmp_eq_u32 vcc, s43, v9
  s_cmp_eq_u32 s47, 0
  s_cbranch_scc1 k23_kernel_zo7
  s_nop 2
  s_cbranch_vccz k23_kernel_zo7
  s_sub_u32 s47, s47, 1
  s_sleep 4
  s_add_u32 m0, s46, 14336
  s_add_u32 s44, s45, 14336
  buffer_load_dwordx4 v13, s[12:15], s44 offen sc1 lds
  s_add_u32 m0, s46, 15360
  s_add_u32 s44, s45, 15360
  buffer_load_dwordx4 v13, s[12:15], s44 offen sc1 lds
  s_waitcnt vmcnt(0)
  ds_read_b64_tr_b16 v[128:129], v19 offset:14336
  ds_read_b64_tr_b16 v[130:131], v19 offset:15360
  ds_read_b64_tr_b16 v[160:161], v18 offset:14336
  ds_read_b64_tr_b16 v[162:163], v18 offset:15360
  s_waitcnt lgkmcnt(0)
  s_branch k23_kernel_zc7
k23_kernel_zo7:
  v_mfma_f32_32x32x16_bf16 v[84:99], v[224:227], v[128:131], v[84:99]
  v_mfma_f32_32x32x16_bf16 v[52:67], v[220:223], v[128:131], v[52:67]
  v_mfma_f32_32x32x16_bf16 v[68:83], v[224:227], v[160:163], v[68:83]
  v_mfma_f32_32x32x16_bf16 v[36:51], v[164:167], v[132:135], v[36:51]
  v_mfma_f32_32x32x16_bf16 v[36:51], v[172:175], v[136:139], v[36:51]
  s_nop 7
  ds_write_b128 v4, v[84:87] offset:8192
  ds_write_b128 v4, v[88:91] offset:9216
  ds_write_b128 v4, v[92:95] offset:10240
  ds_write_b128 v4, v[96:99] offset:11264
  v_mfma_f32_32x32x16_bf16 v[36:51], v[180:183], v[140:143], v[36:51]
  ds_write_b128 v4, v[52:55] offset:0
  ds_write_b128 v4, v[56:59] offset:1024
  ds_write_b128 v4, v[60:63] offset:2048
  ds_write_b128 v4, v[64:67] offset:3072
  v_mfma_f32_32x32x16_bf16 v[36:51], v[188:191], v[144:147], v[36:51]
  ds_write_b128 v4, v[68:71] offset:4096
  ds_write_b128 v4, v[72:75] offset:5120
  ds_write_b128 v4, v[76:79] offset:6144
  ds_write_b128 v4, v[80:83] offset:7168
  v_mfma_f32_32x32x16_bf16 v[36:51], v[196:199], v[148:151], v[36:51]
  ds_write_b32 v8, v17
  v_mfma_f32_32x32x16_bf16 v[36:51], v[204:207], v[152:155], v[36:51]
  v_mfma_f32_32x32x16_bf16 v[36:51], v[212:215], v[156:159], v[36:51]
  v_mfma_f32_32x32x16_bf16 v[36:51], v[220:223], v[160:163], v[36:51]
k23_kernel_zsp:
  ds_read_b32 v9, v16
  s_waitcnt lgkmcnt(0)
  v_cmp_eq_u32 vcc, 0, v9
  s_nop 3
  s_cbranch_vccnz k23_kernel_zsp
  ds_read_b128 v[52:55], v5 offset:0
  ds_read_b128 v[56:59], v5 offset:1024
  ds_read_b128 v[60:63], v5 offset:2048
  ds_read_b128 v[64:67], v5 offset:3072
  ds_read_b128 v[68:71], v6 offset:0
  ds_read_b128 v[72:75], v6 offset:1024
  ds_read_b128 v[76:79], v6 offset:2048
  ds_read_b128 v[80:83], v6 offset:3072
  ds_read_b128 v[84:87], v7 offset:0
  ds_read_b128 v[88:91], v7 offset:1024
  ds_read_b128 v[92:95], v7 offset:2048
  ds_read_b128 v[96:99], v7 offset:3072
  s_waitcnt lgkmcnt(8)
  v_add_f32 v36, v36, v52
  v_add_f32 v37, v37, v53
  v_add_f32 v38, v38, v54
  v_add_f32 v39, v39, v55
  v_add_f32 v40, v40, v56
  v_add_f32 v41, v41, v57
  v_add_f32 v42, v42, v58
  v_add_f32 v43, v43, v59
  v_add_f32 v44, v44, v60
  v_add_f32 v45, v45, v61
  v_add_f32 v46, v46, v62
  v_add_f32 v47, v47, v63
  v_add_f32 v48, v48, v64
  v_add_f32 v49, v49, v65
  v_add_f32 v50, v50, v66
  v_add_f32 v51, v51, v67
  s_waitcnt lgkmcnt(0)
  v_add_f32 v68, v68, v84
  v_add_f32 v69, v69, v85
  v_add_f32 v70, v70, v86
  v_add_f32 v71, v71, v87
  v_add_f32 v72, v72, v88
  v_add_f32 v73, v73, v89
  v_add_f32 v74, v74, v90
  v_add_f32 v75, v75, v91
  v_add_f32 v76, v76, v92
  v_add_f32 v77, v77, v93
  v_add_f32 v78, v78, v94
  v_add_f32 v79, v79, v95
  v_add_f32 v80, v80, v96
  v_add_f32 v81, v81, v97
  v_add_f32 v82, v82, v98
  v_add_f32 v83, v83, v99
  v_add_f32 v36, v36, v68
  v_add_f32 v37, v37, v69
  v_add_f32 v38, v38, v70
  v_add_f32 v39, v39, v71
  ds_write_b128 v4, v[36:39] offset:12288
  v_add_f32 v40, v40, v72
  v_add_f32 v41, v41, v73
  v_add_f32 v42, v42, v74
  v_add_f32 v43, v43, v75
  ds_write_b128 v4, v[40:43] offset:13312
  v_add_f32 v44, v44, v76
  v_add_f32 v45, v45, v77
  v_add_f32 v46, v46, v78
  v_add_f32 v47, v47, v79
  ds_write_b128 v4, v[44:47] offset:14336
  v_add_f32 v48, v48, v80
  v_add_f32 v49, v49, v81
  v_add_f32 v50, v50, v82
  v_add_f32 v51, v51, v83
  ds_write_b128 v4, v[48:51] offset:15360
  s_waitcnt lgkmcnt(0)
  s_endpgm
k23_kernel_gemm:
  s_setprio 0
  s_and_b32 s37, s2, 7
  s_lshl_b32 s37, s37, 2
  s_bfe_u32 s43, s2, 0x20003
  s_add_u32 s37, s37, s43
  s_lshr_b32 s38, s2, 5
  s_and_b32 s39, s36, 1
  s_lshr_b32 s40, s36, 1
  v_lshlrev_b32 v12, 4, v1
  v_lshrrev_b32 v4, 3, v1
  v_bfe_u32 v5, v1, 4, 1
  v_lshlrev_b32 v5, 2, v5
  v_and_b32 v6, 7, v1
  v_xor_b32 v5, v5, v6
  v_lshlrev_b32 v5, 4, v5
  v_lshl_add_u32 v13, v4, 7, v5
  s_mul_i32 s44, s37, 224
  s_mul_i32 s42, s36, 28
  s_add_u32 s44, s44, s42
  s_mul_i32 s43, s39, 112
  s_sub_u32 s45, s44, s43
  s_add_u32 s45, s45, 112
  s_add_u32 s44, s44, s43
  s_lshl_b32 s44, s44, 10
  s_lshl_b32 s45, s45, 10
  s_lshl_b32 s46, s42, 11
  s_mul_i32 s42, s38, 229376
  s_add_u32 s46, s46, 16777216
  s_add_u32 s46, s46, s42
  s_add_u32 s47, s46, 1024
  s_mul_i32 s48, s36, 14336
  s_add_u32 s48, s48, 65536
  s_waitcnt lgkmcnt(0)
  s_mov_b32 s12, s26
  s_and_b32 s13, s27, 0xffff
  s_mov_b32 s14, 18874368
  s_mov_b32 s15, 0x00020000
  s_mov_b32 s8, s28
  s_and_b32 s9, s29, 0xffff
  s_mov_b32 s10, 1835008
  s_mov_b32 s11, 0x00020000
  s_mov_b32 s16, s30
  s_and_b32 s17, s31, 0xffff
  s_mov_b32 s18, 2097152
  s_mov_b32 s19, 0x00020000
  s_barrier
  s_add_u32 m0, s48, 0
  buffer_load_dwordx4 v[92:95], v12, s[12:15], s44 offen offset:0
  buffer_load_dwordx4 v13, s[12:15], s46 offen lds
  s_add_u32 m0, s48, 1024
  s_add_u32 s46, s46, 2048
  buffer_load_dwordx4 v13, s[12:15], s47 offen lds
  s_add_u32 s47, s47, 2048
  buffer_load_dwordx4 v[96:99], v12, s[12:15], s45 offen offset:0
  s_add_u32 m0, s48, 2048
  buffer_load_dwordx4 v[100:103], v12, s[12:15], s44 offen offset:1024
  buffer_load_dwordx4 v13, s[12:15], s46 offen lds
  s_add_u32 m0, s48, 3072
  s_add_u32 s46, s46, 2048
  buffer_load_dwordx4 v13, s[12:15], s47 offen lds
  s_add_u32 s47, s47, 2048
  buffer_load_dwordx4 v[104:107], v12, s[12:15], s45 offen offset:1024
  v_and_b32 v2, 31, v1
  v_lshrrev_b32 v3, 5, v1
  v_bfe_u32 v4, v1, 2, 2
  v_and_b32 v5, 3, v1
  v_bfe_u32 v6, v1, 4, 1
  v_lshl_add_u32 v7, v3, 2, v4
  v_lshlrev_b32 v7, 7, v7
  v_lshrrev_b32 v4, 1, v4
  v_xor_b32 v8, s40, v4
  v_lshl_add_u32 v8, v8, 6, v7
  v_add_u32 v8, s48, v8
  v_and_b32 v9, 1, v5
  v_lshl_add_u32 v8, v9, 5, v8
  v_lshl_add_u32 v8, v6, 4, v8
  v_lshrrev_b32 v9, 1, v5
  v_lshl_add_u32 v14, v9, 3, v8
  v_xor_b32 v15, 64, v14
  s_add_u32 m0, s48, 4096
  buffer_load_dwordx4 v[108:111], v12, s[12:15], s44 offen offset:2048
  buffer_load_dwordx4 v13, s[12:15], s46 offen lds
  s_add_u32 m0, s48, 5120
  s_add_u32 s46, s46, 2048
  buffer_load_dwordx4 v13, s[12:15], s47 offen lds
  s_add_u32 s47, s47, 2048
  buffer_load_dwordx4 v[112:115], v12, s[12:15], s45 offen offset:2048
  s_add_u32 m0, s48, 6144
  buffer_load_dwordx4 v[116:119], v12, s[12:15], s44 offen offset:3072
  buffer_load_dwordx4 v13, s[12:15], s46 offen lds
  s_add_u32 m0, s48, 7168
  s_add_u32 s46, s46, 2048
  buffer_load_dwordx4 v13, s[12:15], s47 offen lds
  s_add_u32 s47, s47, 2048
  buffer_load_dwordx4 v[120:123], v12, s[12:15], s45 offen offset:3072
  s_add_u32 s44, s44, 4096
  s_add_u32 s45, s45, 4096
  s_add_u32 m0, s48, 8192
  buffer_load_dwordx4 v[124:127], v12, s[12:15], s44 offen offset:0
  buffer_load_dwordx4 v13, s[12:15], s46 offen lds
  s_add_u32 m0, s48, 9216
  s_add_u32 s46, s46, 2048
  buffer_load_dwordx4 v13, s[12:15], s47 offen lds
  s_add_u32 s47, s47, 2048
  buffer_load_dwordx4 v[128:131], v12, s[12:15], s45 offen offset:0
  s_add_u32 m0, s48, 10240
  buffer_load_dwordx4 v[132:135], v12, s[12:15], s44 offen offset:1024
  buffer_load_dwordx4 v13, s[12:15], s46 offen lds
  s_add_u32 m0, s48, 11264
  s_add_u32 s46, s46, 2048
  buffer_load_dwordx4 v13, s[12:15], s47 offen lds
  s_add_u32 s47, s47, 2048
  buffer_load_dwordx4 v[136:139], v12, s[12:15], s45 offen offset:1024
  v_lshlrev_b32 v16, 16, v2
  v_lshl_add_u32 v16, v3, 5, v16
  s_lshl_b32 s41, s37, 11
  s_lshl_b32 s42, s39, 10
  s_add_u32 s41, s41, s42
  s_lshl_b32 s42, s38, 7
  s_add_u32 s41, s41, s42
  s_lshl_b32 s42, s40, 6
  s_add_u32 s41, s41, s42
  v_add_u32 v16, s41, v16
  v_add_u32 v4, s48, v12
  s_xor_b32 s42, s36, 1
  s_mul_i32 s41, s42, 14336
  s_add_u32 s41, s41, 65536
  s_add_u32 s41, s41, 0
  v_add_u32 v5, s41, v12
  s_xor_b32 s42, s36, 2
  s_mul_i32 s41, s42, 14336
  s_add_u32 s41, s41, 65536
  s_add_u32 s41, s41, 4096
  v_add_u32 v6, s41, v12
  s_xor_b32 s42, s36, 3
  s_mul_i32 s41, s42, 14336
  s_add_u32 s41, s41, 65536
  s_add_u32 s41, s41, 8192
  v_add_u32 v7, s41, v12
  s_lshl_b32 s41, s36, 14
  s_add_u32 s41, s41, 12288
  v_add_u32 v8, s41, v12
  s_waitcnt vmcnt(20)
  ds_read_b64_tr_b16 v[156:157], v14 offset:0
  ds_read_b64_tr_b16 v[158:159], v14 offset:1024
  ds_read_b64_tr_b16 v[160:161], v15 offset:0
  ds_read_b64_tr_b16 v[162:163], v15 offset:1024
  s_waitcnt vmcnt(16) lgkmcnt(0)
  ds_read_b64_tr_b16 v[164:165], v14 offset:2048
  ds_read_b64_tr_b16 v[166:167], v14 offset:3072
  ds_read_b64_tr_b16 v[168:169], v15 offset:2048
  ds_read_b64_tr_b16 v[170:171], v15 offset:3072
  v_mfma_f32_32x32x16_bf16 v[76:91], v[160:163], v[96:99], 0
  s_add_u32 m0, s48, 12288
  buffer_load_dwordx4 v[140:143], v12, s[12:15], s44 offen offset:2048
  v_mfma_f32_32x32x16_bf16 v[44:59], v[156:159], v[96:99], 0
  buffer_load_dwordx4 v13, s[12:15], s46 offen lds
  s_add_u32 m0, s48, 13312
  s_add_u32 s46, s46, 2048
  v_mfma_f32_32x32x16_bf16 v[60:75], v[160:163], v[92:95], 0
  buffer_load_dwordx4 v13, s[12:15], s47 offen lds
  s_add_u32 s47, s47, 2048
  v_mfma_f32_32x32x16_bf16 v[28:43], v[156:159], v[92:95], 0
  buffer_load_dwordx4 v[144:147], v12, s[12:15], s45 offen offset:2048
  s_waitcnt vmcnt(16) lgkmcnt(0)
  ds_read_b64_tr_b16 v[156:157], v14 offset:4096
  ds_read_b64_tr_b16 v[158:159], v14 offset:5120
  ds_read_b64_tr_b16 v[160:161], v15 offset:4096
  ds_read_b64_tr_b16 v[162:163], v15 offset:5120
  v_mfma_f32_32x32x16_bf16 v[76:91], v[168:171], v[104:107], v[76:91]
  s_add_u32 m0, s48, 0
  buffer_load_dwordx4 v[92:95], v12, s[12:15], s44 offen offset:3072
  v_mfma_f32_32x32x16_bf16 v[44:59], v[164:167], v[104:107], v[44:59]
  buffer_load_dwordx4 v13, s[12:15], s46 offen lds
  s_add_u32 m0, s48, 1024
  s_add_u32 s46, s46, 2048
  v_mfma_f32_32x32x16_bf16 v[60:75], v[168:171], v[100:103], v[60:75]
  buffer_load_dwordx4 v13, s[12:15], s47 offen lds
  s_add_u32 s47, s47, 2048
  v_mfma_f32_32x32x16_bf16 v[28:43], v[164:167], v[100:103], v[28:43]
  buffer_load_dwordx4 v[96:99], v12, s[12:15], s45 offen offset:3072
  s_add_u32 s44, s44, 4096
  s_add_u32 s45, s45, 4096
  s_waitcnt vmcnt(16) lgkmcnt(0)
  ds_read_b64_tr_b16 v[164:165], v14 offset:6144
  ds_read_b64_tr_b16 v[166:167], v14 offset:7168
  ds_read_b64_tr_b16 v[168:169], v15 offset:6144
  ds_read_b64_tr_b16 v[170:171], v15 offset:7168
  v_mfma_f32_32x32x16_bf16 v[76:91], v[160:163], v[112:115], v[76:91]
  s_add_u32 m0, s48, 2048
  buffer_load_dwordx4 v[100:103], v12, s[12:15], s44 offen offset:0
  v_mfma_f32_32x32x16_bf16 v[44:59], v[156:159], v[112:115], v[44:59]
  buffer_load_dwordx4 v13, s[12:15], s46 offen lds
  s_add_u32 m0, s48, 3072
  s_add_u32 s46, s46, 2048
  v_mfma_f32_32x32x16_bf16 v[60:75], v[160:163], v[108:111], v[60:75]
  buffer_load_dwordx4 v13, s[12:15], s47 offen lds
  s_add_u32 s47, s47, 2048
  v_mfma_f32_32x32x16_bf16 v[28:43], v[156:159], v[108:111], v[28:43]
  buffer_load_dwordx4 v[104:107], v12, s[12:15], s45 offen offset:0
  s_waitcnt vmcnt(16) lgkmcnt(0)
  ds_read_b64_tr_b16 v[156:157], v14 offset:8192
  ds_read_b64_tr_b16 v[158:159], v14 offset:9216
  ds_read_b64_tr_b16 v[160:161], v15 offset:8192
  ds_read_b64_tr_b16 v[162:163], v15 offset:9216
  v_mfma_f32_32x32x16_bf16 v[76:91], v[168:171], v[120:123], v[76:91]
  s_add_u32 m0, s48, 4096
  buffer_load_dwordx4 v[108:111], v12, s[12:15], s44 offen offset:1024
  v_mfma_f32_32x32x16_bf16 v[44:59], v[164:167], v[120:123], v[44:59]
  buffer_load_dwordx4 v13, s[12:15], s46 offen lds
  s_add_u32 m0, s48, 5120
  s_add_u32 s46, s46, 2048
  v_mfma_f32_32x32x16_bf16 v[60:75], v[168:171], v[116:119], v[60:75]
  buffer_load_dwordx4 v13, s[12:15], s47 offen lds
  s_add_u32 s47, s47, 2048
  v_mfma_f32_32x32x16_bf16 v[28:43], v[164:167], v[116:119], v[28:43]
  buffer_load_dwordx4 v[112:115], v12, s[12:15], s45 offen offset:1024
  s_waitcnt vmcnt(16) lgkmcnt(0)
  ds_read_b64_tr_b16 v[164:165], v14 offset:10240
  ds_read_b64_tr_b16 v[166:167], v14 offset:11264
  ds_read_b64_tr_b16 v[168:169], v15 offset:10240
  ds_read_b64_tr_b16 v[170:171], v15 offset:11264
  v_mfma_f32_32x32x16_bf16 v[76:91], v[160:163], v[128:131], v[76:91]
  s_add_u32 m0, s48, 6144
  buffer_load_dwordx4 v[116:119], v12, s[12:15], s44 offen offset:2048
  v_mfma_f32_32x32x16_bf16 v[44:59], v[156:159], v[128:131], v[44:59]
  buffer_load_dwordx4 v13, s[12:15], s46 offen lds
  s_add_u32 m0, s48, 7168
  s_add_u32 s46, s46, 2048
  v_mfma_f32_32x32x16_bf16 v[60:75], v[160:163], v[124:127], v[60:75]
  buffer_load_dwordx4 v13, s[12:15], s47 offen lds
  s_add_u32 s47, s47, 2048
  v_mfma_f32_32x32x16_bf16 v[28:43], v[156:159], v[124:127], v[28:43]
  buffer_load_dwordx4 v[120:123], v12, s[12:15], s45 offen offset:2048
  s_waitcnt vmcnt(16) lgkmcnt(0)
  ds_read_b64_tr_b16 v[156:157], v14 offset:12288
  ds_read_b64_tr_b16 v[158:159], v14 offset:13312
  ds_read_b64_tr_b16 v[160:161], v15 offset:12288
  ds_read_b64_tr_b16 v[162:163], v15 offset:13312
  v_mfma_f32_32x32x16_bf16 v[76:91], v[168:171], v[136:139], v[76:91]
  s_add_u32 m0, s48, 8192
  buffer_load_dwordx4 v[124:127], v12, s[12:15], s44 offen offset:3072
  v_mfma_f32_32x32x16_bf16 v[44:59], v[164:167], v[136:139], v[44:59]
  buffer_load_dwordx4 v13, s[12:15], s46 offen lds
  s_add_u32 m0, s48, 9216
  s_add_u32 s46, s46, 2048
  v_mfma_f32_32x32x16_bf16 v[60:75], v[168:171], v[132:135], v[60:75]
  buffer_load_dwordx4 v13, s[12:15], s47 offen lds
  s_add_u32 s47, s47, 2048
  v_mfma_f32_32x32x16_bf16 v[28:43], v[164:167], v[132:135], v[28:43]
  buffer_load_dwordx4 v[128:131], v12, s[12:15], s45 offen offset:3072
  s_add_u32 s44, s44, 4096
  s_add_u32 s45, s45, 4096
  s_waitcnt vmcnt(16) lgkmcnt(0)
  ds_read_b64_tr_b16 v[164:165], v14 offset:0
  ds_read_b64_tr_b16 v[166:167], v14 offset:1024
  ds_read_b64_tr_b16 v[168:169], v15 offset:0
  ds_read_b64_tr_b16 v[170:171], v15 offset:1024
  v_mfma_f32_32x32x16_bf16 v[76:91], v[160:163], v[144:147], v[76:91]
  s_add_u32 m0, s48, 10240
  buffer_load_dwordx4 v[132:135], v12, s[12:15], s44 offen offset:0
  v_mfma_f32_32x32x16_bf16 v[44:59], v[156:159], v[144:147], v[44:59]
  buffer_load_dwordx4 v13, s[12:15], s46 offen lds
  s_add_u32 m0, s48, 11264
  s_add_u32 s46, s46, 2048
  v_mfma_f32_32x32x16_bf16 v[60:75], v[160:163], v[140:143], v[60:75]
  buffer_load_dwordx4 v13, s[12:15], s47 offen lds
  s_add_u32 s47, s47, 2048
  v_mfma_f32_32x32x16_bf16 v[28:43], v[156:159], v[140:143], v[28:43]
  buffer_load_dwordx4 v[136:139], v12, s[12:15], s45 offen offset:0
  s_waitcnt vmcnt(16) lgkmcnt(0)
  ds_read_b64_tr_b16 v[156:157], v14 offset:2048
  ds_read_b64_tr_b16 v[158:159], v14 offset:3072
  ds_read_b64_tr_b16 v[160:161], v15 offset:2048
  ds_read_b64_tr_b16 v[162:163], v15 offset:3072
  v_mfma_f32_32x32x16_bf16 v[76:91], v[168:171], v[96:99], v[76:91]
  s_add_u32 m0, s48, 12288
  buffer_load_dwordx4 v[140:143], v12, s[12:15], s44 offen offset:1024
  v_mfma_f32_32x32x16_bf16 v[44:59], v[164:167], v[96:99], v[44:59]
  buffer_load_dwordx4 v13, s[12:15], s46 offen lds
  s_add_u32 m0, s48, 13312
  s_add_u32 s46, s46, 2048
  v_mfma_f32_32x32x16_bf16 v[60:75], v[168:171], v[92:95], v[60:75]
  buffer_load_dwordx4 v13, s[12:15], s47 offen lds
  s_add_u32 s47, s47, 2048
  v_mfma_f32_32x32x16_bf16 v[28:43], v[164:167], v[92:95], v[28:43]
  buffer_load_dwordx4 v[144:147], v12, s[12:15], s45 offen offset:1024
  s_waitcnt vmcnt(16) lgkmcnt(0)
  ds_read_b64_tr_b16 v[164:165], v14 offset:4096
  ds_read_b64_tr_b16 v[166:167], v14 offset:5120
  ds_read_b64_tr_b16 v[168:169], v15 offset:4096
  ds_read_b64_tr_b16 v[170:171], v15 offset:5120
  v_mfma_f32_32x32x16_bf16 v[76:91], v[160:163], v[104:107], v[76:91]
  s_add_u32 m0, s48, 0
  buffer_load_dwordx4 v[92:95], v12, s[12:15], s44 offen offset:2048
  v_mfma_f32_32x32x16_bf16 v[44:59], v[156:159], v[104:107], v[44:59]
  buffer_load_dwordx4 v13, s[12:15], s46 offen lds
  s_add_u32 m0, s48, 1024
  s_add_u32 s46, s46, 2048
  v_mfma_f32_32x32x16_bf16 v[60:75], v[160:163], v[100:103], v[60:75]
  buffer_load_dwordx4 v13, s[12:15], s47 offen lds
  s_add_u32 s47, s47, 2048
  v_mfma_f32_32x32x16_bf16 v[28:43], v[156:159], v[100:103], v[28:43]
  buffer_load_dwordx4 v[96:99], v12, s[12:15], s45 offen offset:2048
  s_waitcnt vmcnt(16) lgkmcnt(0)
  ds_read_b64_tr_b16 v[156:157], v14 offset:6144
  ds_read_b64_tr_b16 v[158:159], v14 offset:7168
  ds_read_b64_tr_b16 v[160:161], v15 offset:6144
  ds_read_b64_tr_b16 v[162:163], v15 offset:7168
  v_mfma_f32_32x32x16_bf16 v[76:91], v[168:171], v[112:115], v[76:91]
  s_add_u32 m0, s48, 2048
  buffer_load_dwordx4 v[100:103], v12, s[12:15], s44 offen offset:3072
  v_mfma_f32_32x32x16_bf16 v[44:59], v[164:167], v[112:115], v[44:59]
  buffer_load_dwordx4 v13, s[12:15], s46 offen lds
  s_add_u32 m0, s48, 3072
  s_add_u32 s46, s46, 2048
  v_mfma_f32_32x32x16_bf16 v[60:75], v[168:171], v[108:111], v[60:75]
  buffer_load_dwordx4 v13, s[12:15], s47 offen lds
  s_add_u32 s47, s47, 2048
  v_mfma_f32_32x32x16_bf16 v[28:43], v[164:167], v[108:111], v[28:43]
  buffer_load_dwordx4 v[104:107], v12, s[12:15], s45 offen offset:3072
  s_add_u32 s44, s44, 4096
  s_add_u32 s45, s45, 4096
  s_waitcnt vmcnt(16) lgkmcnt(0)
  ds_read_b64_tr_b16 v[164:165], v14 offset:8192
  ds_read_b64_tr_b16 v[166:167], v14 offset:9216
  ds_read_b64_tr_b16 v[168:169], v15 offset:8192
  ds_read_b64_tr_b16 v[170:171], v15 offset:9216
  v_mfma_f32_32x32x16_bf16 v[76:91], v[160:163], v[120:123], v[76:91]
  s_add_u32 m0, s48, 4096
  buffer_load_dwordx4 v[108:111], v12, s[12:15], s44 offen offset:0
  v_mfma_f32_32x32x16_bf16 v[44:59], v[156:159], v[120:123], v[44:59]
  buffer_load_dwordx4 v13, s[12:15], s46 offen lds
  s_add_u32 m0, s48, 5120
  s_add_u32 s46, s46, 2048
  v_mfma_f32_32x32x16_bf16 v[60:75], v[160:163], v[116:119], v[60:75]
  buffer_load_dwordx4 v13, s[12:15], s47 offen lds
  s_add_u32 s47, s47, 2048
  v_mfma_f32_32x32x16_bf16 v[28:43], v[156:159], v[116:119], v[28:43]
  buffer_load_dwordx4 v[112:115], v12, s[12:15], s45 offen offset:0
  s_waitcnt vmcnt(16) lgkmcnt(0)
  ds_read_b64_tr_b16 v[156:157], v14 offset:10240
  ds_read_b64_tr_b16 v[158:159], v14 offset:11264
  ds_read_b64_tr_b16 v[160:161], v15 offset:10240
  ds_read_b64_tr_b16 v[162:163], v15 offset:11264
  v_mfma_f32_32x32x16_bf16 v[76:91], v[168:171], v[128:131], v[76:91]
  s_add_u32 m0, s48, 6144
  buffer_load_dwordx4 v[116:119], v12, s[12:15], s44 offen offset:1024
  v_mfma_f32_32x32x16_bf16 v[44:59], v[164:167], v[128:131], v[44:59]
  buffer_load_dwordx4 v13, s[12:15], s46 offen lds
  s_add_u32 m0, s48, 7168
  s_add_u32 s46, s46, 2048
  v_mfma_f32_32x32x16_bf16 v[60:75], v[168:171], v[124:127], v[60:75]
  buffer_load_dwordx4 v13, s[12:15], s47 offen lds
  s_add_u32 s47, s47, 2048
  v_mfma_f32_32x32x16_bf16 v[28:43], v[164:167], v[124:127], v[28:43]
  buffer_load_dwordx4 v[120:123], v12, s[12:15], s45 offen offset:1024
  s_waitcnt vmcnt(16) lgkmcnt(0)
  ds_read_b64_tr_b16 v[164:165], v14 offset:12288
  ds_read_b64_tr_b16 v[166:167], v14 offset:13312
  ds_read_b64_tr_b16 v[168:169], v15 offset:12288
  ds_read_b64_tr_b16 v[170:171], v15 offset:13312
  v_mfma_f32_32x32x16_bf16 v[76:91], v[160:163], v[136:139], v[76:91]
  s_add_u32 m0, s48, 8192
  buffer_load_dwordx4 v[124:127], v12, s[12:15], s44 offen offset:2048
  v_mfma_f32_32x32x16_bf16 v[44:59], v[156:159], v[136:139], v[44:59]
  buffer_load_dwordx4 v13, s[12:15], s46 offen lds
  s_add_u32 m0, s48, 9216
  s_add_u32 s46, s46, 2048
  v_mfma_f32_32x32x16_bf16 v[60:75], v[160:163], v[132:135], v[60:75]
  buffer_load_dwordx4 v13, s[12:15], s47 offen lds
  s_add_u32 s47, s47, 2048
  v_mfma_f32_32x32x16_bf16 v[28:43], v[156:159], v[132:135], v[28:43]
  buffer_load_dwordx4 v[128:131], v12, s[12:15], s45 offen offset:2048
  s_waitcnt vmcnt(16) lgkmcnt(0)
  ds_read_b64_tr_b16 v[156:157], v14 offset:0
  ds_read_b64_tr_b16 v[158:159], v14 offset:1024
  ds_read_b64_tr_b16 v[160:161], v15 offset:0
  ds_read_b64_tr_b16 v[162:163], v15 offset:1024
  v_mfma_f32_32x32x16_bf16 v[76:91], v[168:171], v[144:147], v[76:91]
  s_add_u32 m0, s48, 10240
  buffer_load_dwordx4 v[132:135], v12, s[12:15], s44 offen offset:3072
  v_mfma_f32_32x32x16_bf16 v[44:59], v[164:167], v[144:147], v[44:59]
  buffer_load_dwordx4 v13, s[12:15], s46 offen lds
  s_add_u32 m0, s48, 11264
  s_add_u32 s46, s46, 2048
  v_mfma_f32_32x32x16_bf16 v[60:75], v[168:171], v[140:143], v[60:75]
  buffer_load_dwordx4 v13, s[12:15], s47 offen lds
  s_add_u32 s47, s47, 2048
  v_mfma_f32_32x32x16_bf16 v[28:43], v[164:167], v[140:143], v[28:43]
  buffer_load_dwordx4 v[136:139], v12, s[12:15], s45 offen offset:3072
  s_add_u32 s44, s44, 4096
  s_add_u32 s45, s45, 4096
  s_waitcnt vmcnt(16) lgkmcnt(0)
  ds_read_b64_tr_b16 v[164:165], v14 offset:2048
  ds_read_b64_tr_b16 v[166:167], v14 offset:3072
  ds_read_b64_tr_b16 v[168:169], v15 offset:2048
  ds_read_b64_tr_b16 v[170:171], v15 offset:3072
  v_mfma_f32_32x32x16_bf16 v[76:91], v[160:163], v[96:99], v[76:91]
  s_add_u32 m0, s48, 12288
  buffer_load_dwordx4 v[140:143], v12, s[12:15], s44 offen offset:0
  v_mfma_f32_32x32x16_bf16 v[44:59], v[156:159], v[96:99], v[44:59]
  buffer_load_dwordx4 v13, s[12:15], s46 offen lds
  s_add_u32 m0, s48, 13312
  s_add_u32 s46, s46, 2048
  v_mfma_f32_32x32x16_bf16 v[60:75], v[160:163], v[92:95], v[60:75]
  buffer_load_dwordx4 v13, s[12:15], s47 offen lds
  s_add_u32 s47, s47, 2048
  v_mfma_f32_32x32x16_bf16 v[28:43], v[156:159], v[92:95], v[28:43]
  buffer_load_dwordx4 v[144:147], v12, s[12:15], s45 offen offset:0
  s_waitcnt vmcnt(16) lgkmcnt(0)
  ds_read_b64_tr_b16 v[156:157], v14 offset:4096
  ds_read_b64_tr_b16 v[158:159], v14 offset:5120
  ds_read_b64_tr_b16 v[160:161], v15 offset:4096
  ds_read_b64_tr_b16 v[162:163], v15 offset:5120
  v_mfma_f32_32x32x16_bf16 v[76:91], v[168:171], v[104:107], v[76:91]
  s_add_u32 m0, s48, 0
  buffer_load_dwordx4 v[92:95], v12, s[12:15], s44 offen offset:1024
  v_mfma_f32_32x32x16_bf16 v[44:59], v[164:167], v[104:107], v[44:59]
  buffer_load_dwordx4 v13, s[12:15], s46 offen lds
  s_add_u32 m0, s48, 1024
  s_add_u32 s46, s46, 2048
  v_mfma_f32_32x32x16_bf16 v[60:75], v[168:171], v[100:103], v[60:75]
  buffer_load_dwordx4 v13, s[12:15], s47 offen lds
  s_add_u32 s47, s47, 2048
  v_mfma_f32_32x32x16_bf16 v[28:43], v[164:167], v[100:103], v[28:43]
  buffer_load_dwordx4 v[96:99], v12, s[12:15], s45 offen offset:1024
  s_waitcnt vmcnt(16) lgkmcnt(0)
  ds_read_b64_tr_b16 v[164:165], v14 offset:6144
  ds_read_b64_tr_b16 v[166:167], v14 offset:7168
  ds_read_b64_tr_b16 v[168:169], v15 offset:6144
  ds_read_b64_tr_b16 v[170:171], v15 offset:7168
  v_mfma_f32_32x32x16_bf16 v[76:91], v[160:163], v[112:115], v[76:91]
  s_add_u32 m0, s48, 2048
  buffer_load_dwordx4 v[100:103], v12, s[12:15], s44 offen offset:2048
  v_mfma_f32_32x32x16_bf16 v[44:59], v[156:159], v[112:115], v[44:59]
  buffer_load_dwordx4 v13, s[12:15], s46 offen lds
  s_add_u32 m0, s48, 3072
  s_add_u32 s46, s46, 2048
  v_mfma_f32_32x32x16_bf16 v[60:75], v[160:163], v[108:111], v[60:75]
  buffer_load_dwordx4 v13, s[12:15], s47 offen lds
  s_add_u32 s47, s47, 2048
  v_mfma_f32_32x32x16_bf16 v[28:43], v[156:159], v[108:111], v[28:43]
  buffer_load_dwordx4 v[104:107], v12, s[12:15], s45 offen offset:2048
  s_waitcnt vmcnt(16) lgkmcnt(0)
  ds_read_b64_tr_b16 v[156:157], v14 offset:8192
  ds_read_b64_tr_b16 v[158:159], v14 offset:9216
  ds_read_b64_tr_b16 v[160:161], v15 offset:8192
  ds_read_b64_tr_b16 v[162:163], v15 offset:9216
  v_mfma_f32_32x32x16_bf16 v[76:91], v[168:171], v[120:123], v[76:91]
  s_add_u32 m0, s48, 4096
  buffer_load_dwordx4 v[108:111], v12, s[12:15], s44 offen offset:3072
  v_mfma_f32_32x32x16_bf16 v[44:59], v[164:167], v[120:123], v[44:59]
  buffer_load_dwordx4 v13, s[12:15], s46 offen lds
  s_add_u32 m0, s48, 5120
  s_add_u32 s46, s46, 2048
  v_mfma_f32_32x32x16_bf16 v[60:75], v[168:171], v[116:119], v[60:75]
  buffer_load_dwordx4 v13, s[12:15], s47 offen lds
  s_add_u32 s47, s47, 2048
  v_mfma_f32_32x32x16_bf16 v[28:43], v[164:167], v[116:119], v[28:43]
  buffer_load_dwordx4 v[112:115], v12, s[12:15], s45 offen offset:3072
  s_add_u32 s44, s44, 4096
  s_add_u32 s45, s45, 4096
  s_waitcnt vmcnt(16) lgkmcnt(0)
  ds_read_b64_tr_b16 v[164:165], v14 offset:10240
  ds_read_b64_tr_b16 v[166:167], v14 offset:11264
  ds_read_b64_tr_b16 v[168:169], v15 offset:10240
  ds_read_b64_tr_b16 v[170:171], v15 offset:11264
  v_mfma_f32_32x32x16_bf16 v[76:91], v[160:163], v[128:131], v[76:91]
  s_add_u32 m0, s48, 6144
  buffer_load_dwordx4 v[116:119], v12, s[12:15], s44 offen offset:0
  v_mfma_f32_32x32x16_bf16 v[44:59], v[156:159], v[128:131], v[44:59]
  buffer_load_dwordx4 v13, s[12:15], s46 offen lds
  s_add_u32 m0, s48, 7168
  s_add_u32 s46, s46, 2048
  v_mfma_f32_32x32x16_bf16 v[60:75], v[160:163], v[124:127], v[60:75]
  buffer_load_dwordx4 v13, s[12:15], s47 offen lds
  s_add_u32 s47, s47, 2048
  v_mfma_f32_32x32x16_bf16 v[28:43], v[156:159], v[124:127], v[28:43]
  buffer_load_dwordx4 v[120:123], v12, s[12:15], s45 offen offset:0
  s_waitcnt vmcnt(16) lgkmcnt(0)
  ds_read_b64_tr_b16 v[156:157], v14 offset:12288
  ds_read_b64_tr_b16 v[158:159], v14 offset:13312
  ds_read_b64_tr_b16 v[160:161], v15 offset:12288
  ds_read_b64_tr_b16 v[162:163], v15 offset:13312
  v_mfma_f32_32x32x16_bf16 v[76:91], v[168:171], v[136:139], v[76:91]
  s_add_u32 m0, s48, 8192
  buffer_load_dwordx4 v[124:127], v12, s[12:15], s44 offen offset:1024
  v_mfma_f32_32x32x16_bf16 v[44:59], v[164:167], v[136:139], v[44:59]
  buffer_load_dwordx4 v13, s[12:15], s46 offen lds
  s_add_u32 m0, s48, 9216
  s_add_u32 s46, s46, 2048
  v_mfma_f32_32x32x16_bf16 v[60:75], v[168:171], v[132:135], v[60:75]
  buffer_load_dwordx4 v13, s[12:15], s47 offen lds
  s_add_u32 s47, s47, 2048
  v_mfma_f32_32x32x16_bf16 v[28:43], v[164:167], v[132:135], v[28:43]
  buffer_load_dwordx4 v[128:131], v12, s[12:15], s45 offen offset:1024
  s_waitcnt vmcnt(16) lgkmcnt(0)
  ds_read_b64_tr_b16 v[164:165], v14 offset:0
  ds_read_b64_tr_b16 v[166:167], v14 offset:1024
  ds_read_b64_tr_b16 v[168:169], v15 offset:0
  ds_read_b64_tr_b16 v[170:171], v15 offset:1024
  v_mfma_f32_32x32x16_bf16 v[76:91], v[160:163], v[144:147], v[76:91]
  s_add_u32 m0, s48, 10240
  buffer_load_dwordx4 v[132:135], v12, s[12:15], s44 offen offset:2048
  v_mfma_f32_32x32x16_bf16 v[44:59], v[156:159], v[144:147], v[44:59]
  buffer_load_dwordx4 v13, s[12:15], s46 offen lds
  s_add_u32 m0, s48, 11264
  s_add_u32 s46, s46, 2048
  v_mfma_f32_32x32x16_bf16 v[60:75], v[160:163], v[140:143], v[60:75]
  buffer_load_dwordx4 v13, s[12:15], s47 offen lds
  s_add_u32 s47, s47, 2048
  v_mfma_f32_32x32x16_bf16 v[28:43], v[156:159], v[140:143], v[28:43]
  buffer_load_dwordx4 v[136:139], v12, s[12:15], s45 offen offset:2048
  s_waitcnt vmcnt(16) lgkmcnt(0)
  ds_read_b64_tr_b16 v[156:157], v14 offset:2048
  ds_read_b64_tr_b16 v[158:159], v14 offset:3072
  ds_read_b64_tr_b16 v[160:161], v15 offset:2048
  ds_read_b64_tr_b16 v[162:163], v15 offset:3072
  v_mfma_f32_32x32x16_bf16 v[76:91], v[168:171], v[96:99], v[76:91]
  s_add_u32 m0, s48, 12288
  buffer_load_dwordx4 v[140:143], v12, s[12:15], s44 offen offset:3072
  v_mfma_f32_32x32x16_bf16 v[44:59], v[164:167], v[96:99], v[44:59]
  buffer_load_dwordx4 v13, s[12:15], s46 offen lds
  s_add_u32 m0, s48, 13312
  s_add_u32 s46, s46, 2048
  v_mfma_f32_32x32x16_bf16 v[60:75], v[168:171], v[92:95], v[60:75]
  buffer_load_dwordx4 v13, s[12:15], s47 offen lds
  s_add_u32 s47, s47, 2048
  v_mfma_f32_32x32x16_bf16 v[28:43], v[164:167], v[92:95], v[28:43]
  buffer_load_dwordx4 v[144:147], v12, s[12:15], s45 offen offset:3072
  s_add_u32 s44, s44, 4096
  s_add_u32 s45, s45, 4096
  s_waitcnt vmcnt(16) lgkmcnt(0)
  ds_read_b64_tr_b16 v[164:165], v14 offset:4096
  ds_read_b64_tr_b16 v[166:167], v14 offset:5120
  ds_read_b64_tr_b16 v[168:169], v15 offset:4096
  ds_read_b64_tr_b16 v[170:171], v15 offset:5120
  v_mfma_f32_32x32x16_bf16 v[76:91], v[160:163], v[104:107], v[76:91]
  v_mfma_f32_32x32x16_bf16 v[44:59], v[156:159], v[104:107], v[44:59]
  v_mfma_f32_32x32x16_bf16 v[60:75], v[160:163], v[100:103], v[60:75]
  v_mfma_f32_32x32x16_bf16 v[28:43], v[156:159], v[100:103], v[28:43]
  s_waitcnt vmcnt(12) lgkmcnt(0)
  ds_read_b64_tr_b16 v[156:157], v14 offset:6144
  ds_read_b64_tr_b16 v[158:159], v14 offset:7168
  ds_read_b64_tr_b16 v[160:161], v15 offset:6144
  ds_read_b64_tr_b16 v[162:163], v15 offset:7168
  v_mfma_f32_32x32x16_bf16 v[76:91], v[168:171], v[112:115], v[76:91]
  v_mfma_f32_32x32x16_bf16 v[44:59], v[164:167], v[112:115], v[44:59]
  v_mfma_f32_32x32x16_bf16 v[60:75], v[168:171], v[108:111], v[60:75]
  v_mfma_f32_32x32x16_bf16 v[28:43], v[164:167], v[108:111], v[28:43]
  s_waitcnt vmcnt(8) lgkmcnt(0)
  ds_read_b64_tr_b16 v[164:165], v14 offset:8192
  ds_read_b64_tr_b16 v[166:167], v14 offset:9216
  ds_read_b64_tr_b16 v[168:169], v15 offset:8192
  ds_read_b64_tr_b16 v[170:171], v15 offset:9216
  v_mfma_f32_32x32x16_bf16 v[76:91], v[160:163], v[120:123], v[76:91]
  v_mfma_f32_32x32x16_bf16 v[44:59], v[156:159], v[120:123], v[44:59]
  v_mfma_f32_32x32x16_bf16 v[60:75], v[160:163], v[116:119], v[60:75]
  v_mfma_f32_32x32x16_bf16 v[28:43], v[156:159], v[116:119], v[28:43]
  s_waitcnt vmcnt(4) lgkmcnt(0)
  ds_read_b64_tr_b16 v[156:157], v14 offset:10240
  ds_read_b64_tr_b16 v[158:159], v14 offset:11264
  ds_read_b64_tr_b16 v[160:161], v15 offset:10240
  ds_read_b64_tr_b16 v[162:163], v15 offset:11264
  v_mfma_f32_32x32x16_bf16 v[76:91], v[168:171], v[128:131], v[76:91]
  v_mfma_f32_32x32x16_bf16 v[44:59], v[164:167], v[128:131], v[44:59]
  v_mfma_f32_32x32x16_bf16 v[60:75], v[168:171], v[124:127], v[60:75]
  v_mfma_f32_32x32x16_bf16 v[28:43], v[164:167], v[124:127], v[28:43]
  s_waitcnt vmcnt(0) lgkmcnt(0)
  ds_read_b64_tr_b16 v[164:165], v14 offset:12288
  ds_read_b64_tr_b16 v[166:167], v14 offset:13312
  ds_read_b64_tr_b16 v[168:169], v15 offset:12288
  ds_read_b64_tr_b16 v[170:171], v15 offset:13312
  v_mfma_f32_32x32x16_bf16 v[76:91], v[160:163], v[136:139], v[76:91]
  v_mfma_f32_32x32x16_bf16 v[44:59], v[156:159], v[136:139], v[44:59]
  v_mfma_f32_32x32x16_bf16 v[60:75], v[160:163], v[132:135], v[60:75]
  v_mfma_f32_32x32x16_bf16 v[28:43], v[156:159], v[132:135], v[28:43]
  s_waitcnt lgkmcnt(0)
  v_mfma_f32_32x32x16_bf16 v[76:91], v[168:171], v[144:147], v[76:91]
  v_mfma_f32_32x32x16_bf16 v[44:59], v[164:167], v[144:147], v[44:59]
  v_mfma_f32_32x32x16_bf16 v[60:75], v[168:171], v[140:143], v[60:75]
  v_mfma_f32_32x32x16_bf16 v[28:43], v[164:167], v[140:143], v[28:43]
  s_nop 8
  ds_write_b128 v4, v[76:79] offset:8192
  ds_write_b128 v4, v[80:83] offset:9216
  ds_write_b128 v4, v[84:87] offset:10240
  ds_write_b128 v4, v[88:91] offset:11264
  ds_write_b128 v4, v[44:47] offset:0
  ds_write_b128 v4, v[48:51] offset:1024
  ds_write_b128 v4, v[52:55] offset:2048
  ds_write_b128 v4, v[56:59] offset:3072
  ds_write_b128 v4, v[60:63] offset:4096
  ds_write_b128 v4, v[64:67] offset:5120
  ds_write_b128 v4, v[68:71] offset:6144
  ds_write_b128 v4, v[72:75] offset:7168
  s_waitcnt lgkmcnt(0)
  s_barrier
  ds_read_b128 v[92:95], v8 offset:0
  ds_read_b128 v[96:99], v8 offset:1024
  ds_read_b128 v[100:103], v8 offset:2048
  ds_read_b128 v[104:107], v8 offset:3072
  ds_read_b128 v[140:143], v7 offset:0
  ds_read_b128 v[144:147], v7 offset:1024
  ds_read_b128 v[148:151], v7 offset:2048
  ds_read_b128 v[152:155], v7 offset:3072
  ds_read_b128 v[108:111], v5 offset:0
  ds_read_b128 v[112:115], v5 offset:1024
  ds_read_b128 v[116:119], v5 offset:2048
  ds_read_b128 v[120:123], v5 offset:3072
  ds_read_b128 v[124:127], v6 offset:0
  ds_read_b128 v[128:131], v6 offset:1024
  ds_read_b128 v[132:135], v6 offset:2048
  ds_read_b128 v[136:139], v6 offset:3072
  s_waitcnt lgkmcnt(12)
  v_add_f32 v28, v28, v92
  v_add_f32 v29, v29, v93
  v_add_f32 v30, v30, v94
  v_add_f32 v31, v31, v95
  v_add_f32 v32, v32, v96
  v_add_f32 v33, v33, v97
  v_add_f32 v34, v34, v98
  v_add_f32 v35, v35, v99
  v_add_f32 v36, v36, v100
  v_add_f32 v37, v37, v101
  v_add_f32 v38, v38, v102
  v_add_f32 v39, v39, v103
  v_add_f32 v40, v40, v104
  v_add_f32 v41, v41, v105
  v_add_f32 v42, v42, v106
  v_add_f32 v43, v43, v107
  s_waitcnt lgkmcnt(4)
  v_add_f32 v140, v140, v108
  v_add_f32 v141, v141, v109
  v_add_f32 v142, v142, v110
  v_add_f32 v143, v143, v111
  v_add_f32 v144, v144, v112
  v_add_f32 v145, v145, v113
  v_add_f32 v146, v146, v114
  v_add_f32 v147, v147, v115
  v_add_f32 v148, v148, v116
  v_add_f32 v149, v149, v117
  v_add_f32 v150, v150, v118
  v_add_f32 v151, v151, v119
  v_add_f32 v152, v152, v120
  v_add_f32 v153, v153, v121
  v_add_f32 v154, v154, v122
  v_add_f32 v155, v155, v123
  s_waitcnt lgkmcnt(0)
  v_add_f32 v28, v28, v124
  v_add_f32 v29, v29, v125
  v_add_f32 v30, v30, v126
  v_add_f32 v31, v31, v127
  v_add_f32 v32, v32, v128
  v_add_f32 v33, v33, v129
  v_add_f32 v34, v34, v130
  v_add_f32 v35, v35, v131
  v_add_f32 v36, v36, v132
  v_add_f32 v37, v37, v133
  v_add_f32 v38, v38, v134
  v_add_f32 v39, v39, v135
  v_add_f32 v40, v40, v136
  v_add_f32 v41, v41, v137
  v_add_f32 v42, v42, v138
  v_add_f32 v43, v43, v139
  v_add_f32 v28, v28, v140
  v_add_f32 v29, v29, v141
  v_add_f32 v30, v30, v142
  v_add_f32 v31, v31, v143
  v_add_f32 v32, v32, v144
  v_add_f32 v33, v33, v145
  v_add_f32 v34, v34, v146
  v_add_f32 v35, v35, v147
  v_cvt_pk_bf16_f32 v20, v28, v29
  v_cvt_pk_bf16_f32 v21, v30, v31
  v_cvt_pk_bf16_f32 v22, v32, v33
  v_cvt_pk_bf16_f32 v23, v34, v35
  buffer_store_dwordx4 v[20:23], v16, s[16:19], 0 offen offset:0
  v_add_f32 v36, v36, v148
  v_add_f32 v37, v37, v149
  v_add_f32 v38, v38, v150
  v_add_f32 v39, v39, v151
  v_add_f32 v40, v40, v152
  v_add_f32 v41, v41, v153
  v_add_f32 v42, v42, v154
  v_add_f32 v43, v43, v155
  v_cvt_pk_bf16_f32 v24, v36, v37
  v_cvt_pk_bf16_f32 v25, v38, v39
  v_cvt_pk_bf16_f32 v26, v40, v41
  v_cvt_pk_bf16_f32 v27, v42, v43
  buffer_store_dwordx4 v[24:27], v16, s[16:19], 0 offen offset:16
k23_kernel_done:
  s_endpgm
k23_end:
.section .rodata,"a"
.p2align 6
.amdhsa_kernel k1_kernel
  .amdhsa_next_free_vgpr 208
  .amdhsa_next_free_sgpr 102
  .amdhsa_accum_offset 208
  .amdhsa_group_segment_fixed_size 0
  .amdhsa_kernarg_size 80
  .amdhsa_user_sgpr_count 2
  .amdhsa_user_sgpr_kernarg_segment_ptr 1
  .amdhsa_system_sgpr_workgroup_id_x 1
.end_amdhsa_kernel

.p2align 6
.amdhsa_kernel k23_kernel
  .amdhsa_next_free_vgpr 248
  .amdhsa_next_free_sgpr 102
  .amdhsa_accum_offset 244
  .amdhsa_group_segment_fixed_size 0
  .amdhsa_kernarg_size 80
  .amdhsa_user_sgpr_count 2
  .amdhsa_user_sgpr_kernarg_segment_ptr 1
  .amdhsa_system_sgpr_workgroup_id_x 1
.end_amdhsa_kernel
.set tw_0, 0x00003f80
.set tw_1, 0xbc493f80
.set tw_2, 0xbcc93f80
.set tw_3, 0xbd173f80
.set tw_4, 0xbd493f80
.set tw_5, 0xbd7b3f80
.set tw_6, 0xbd973f7f
.set tw_7, 0xbdb03f7f
.set tw_8, 0xbdc93f7f
.set tw_9, 0xbde23f7e
.set tw_10, 0xbdfb3f7e
.set tw_11, 0xbe0a3f7e
.set tw_12, 0xbe163f7d
.set tw_13, 0xbe233f7d
.set tw_14, 0xbe2f3f7c
.set tw_15, 0xbe3b3f7c
.set tw_16, 0xbe483f7b
.set tw_17, 0xbe543f7a
.set tw_18, 0xbe603f7a
.set tw_19, 0xbe6d3f79
.set tw_20, 0xbe793f78
.set tw_21, 0xbe823f78
.set tw_22, 0xbe893f77
.set tw_23, 0xbe8f3f76
.set tw_24, 0xbe953f75
.set tw_25, 0xbe9b3f74
.set tw_26, 0xbea13f73
.set tw_27, 0xbea73f72
.set tw_28, 0xbeac3f71
.set tw_29, 0xbeb23f70
.set tw_30, 0xbeb83f6f
.set tw_31, 0xbebe3f6e
.set tw_32, 0xbec43f6d
.set tw_33, 0xbeca3f6b
.set tw_34, 0xbecf3f6a
.set tw_35, 0xbed53f69
.set tw_36, 0xbedb3f67
.set tw_37, 0xbee13f66
.set tw_38, 0xbee63f65
.set tw_39, 0xbeec3f63
.set tw_40, 0xbef13f62
.set tw_41, 0xbef73f60
.set tw_42, 0xbefc3f5f
.set tw_43, 0xbf013f5d
.set tw_44, 0xbf043f5c
.set tw_45, 0xbf063f5a
.set tw_46, 0xbf093f58
.set tw_47, 0xbf0c3f57
.set tw_48, 0xbf0e3f55
.set tw_49, 0xbf113f53
.set tw_50, 0xbf133f51
.set tw_51, 0xbf163f4f
.set tw_52, 0xbf183f4e
.set tw_53, 0xbf1b3f4c
.set tw_54, 0xbf1d3f4a
.set tw_55, 0xbf203f48
.set tw_56, 0xbf223f46
.set tw_57, 0xbf253f44
.set tw_58, 0xbf273f42
.set tw_59, 0xbf2a3f40
.set tw_60, 0xbf2c3f3e
.set tw_61, 0xbf2e3f3c
.set tw_62, 0xbf313f39
.set tw_63, 0xbf333f37
.set tw_64, 0xbf353f35
.set tw_65, 0xbf373f33
.set tw_66, 0xbf393f31
.set tw_67, 0xbf3c3f2e
.set tw_68, 0xbf3e3f2c
.set tw_69, 0xbf403f2a
.set tw_70, 0xbf423f27
.set tw_71, 0xbf443f25
.set tw_72, 0xbf463f22
.set tw_73, 0xbf483f20
.set tw_74, 0xbf4a3f1d
.set tw_75, 0xbf4c3f1b
.set tw_76, 0xbf4e3f18
.set tw_77, 0xbf4f3f16
.set tw_78, 0xbf513f13
.set tw_79, 0xbf533f11
.set tw_80, 0xbf553f0e
.set tw_81, 0xbf573f0c
.set tw_82, 0xbf583f09
.set tw_83, 0xbf5a3f06
.set tw_84, 0xbf5c3f04
.set tw_85, 0xbf5d3f01
.set tw_86, 0xbf5f3efc
.set tw_87, 0xbf603ef7
.set tw_88, 0xbf623ef1
.set tw_89, 0xbf633eec
.set tw_90, 0xbf653ee6
.set tw_91, 0xbf663ee1
.set tw_92, 0xbf673edb
.set tw_93, 0xbf693ed5
.set tw_94, 0xbf6a3ecf
.set tw_95, 0xbf6b3eca
.set tw_96, 0xbf6d3ec4
.set tw_97, 0xbf6e3ebe
.set tw_98, 0xbf6f3eb8
.set tw_99, 0xbf703eb2
.set tw_100, 0xbf713eac
.set tw_101, 0xbf723ea7
.set tw_102, 0xbf733ea1
.set tw_103, 0xbf743e9b
.set tw_104, 0xbf753e95
.set tw_105, 0xbf763e8f
.set tw_106, 0xbf773e89
.set tw_107, 0xbf783e82
.set tw_108, 0xbf783e79
.set tw_109, 0xbf793e6d
.set tw_110, 0xbf7a3e60
.set tw_111, 0xbf7a3e54
.set tw_112, 0xbf7b3e48
.set tw_113, 0xbf7c3e3b
.set tw_114, 0xbf7c3e2f
.set tw_115, 0xbf7d3e23
.set tw_116, 0xbf7d3e16
.set tw_117, 0xbf7e3e0a
.set tw_118, 0xbf7e3dfb
.set tw_119, 0xbf7e3de2
.set tw_120, 0xbf7f3dc9
.set tw_121, 0xbf7f3db0
.set tw_122, 0xbf7f3d97
.set tw_123, 0xbf803d7b
.set tw_124, 0xbf803d49
.set tw_125, 0xbf803d17
.set tw_126, 0xbf803cc9
.set tw_127, 0xbf803c49
.set tw_128, 0xbf800000
.set tw_129, 0xbf80bc49
.set tw_130, 0xbf80bcc9
.set tw_131, 0xbf80bd17
.set tw_132, 0xbf80bd49
.set tw_133, 0xbf80bd7b
.set tw_134, 0xbf7fbd97
.set tw_135, 0xbf7fbdb0
.set tw_136, 0xbf7fbdc9
.set tw_137, 0xbf7ebde2
.set tw_138, 0xbf7ebdfb
.set tw_139, 0xbf7ebe0a
.set tw_140, 0xbf7dbe16
.set tw_141, 0xbf7dbe23
.set tw_142, 0xbf7cbe2f
.set tw_143, 0xbf7cbe3b
.set tw_144, 0xbf7bbe48
.set tw_145, 0xbf7abe54
.set tw_146, 0xbf7abe60
.set tw_147, 0xbf79be6d
.set tw_148, 0xbf78be79
.set tw_149, 0xbf78be82
.set tw_150, 0xbf77be89
.set tw_151, 0xbf76be8f
.set tw_152, 0xbf75be95
.set tw_153, 0xbf74be9b
.set tw_154, 0xbf73bea1
.set tw_155, 0xbf72bea7
.set tw_156, 0xbf71beac
.set tw_157, 0xbf70beb2
.set tw_158, 0xbf6fbeb8
.set tw_159, 0xbf6ebebe
.set tw_160, 0xbf6dbec4
.set tw_161, 0xbf6bbeca
.set tw_162, 0xbf6abecf
.set tw_163, 0xbf69bed5
.set tw_164, 0xbf67bedb
.set tw_165, 0xbf66bee1
.set tw_166, 0xbf65bee6
.set tw_167, 0xbf63beec
.set tw_168, 0xbf62bef1
.set tw_169, 0xbf60bef7
.set tw_170, 0xbf5fbefc
.set tw_171, 0xbf5dbf01
.set tw_172, 0xbf5cbf04
.set tw_173, 0xbf5abf06
.set tw_174, 0xbf58bf09
.set tw_175, 0xbf57bf0c
.set tw_176, 0xbf55bf0e
.set tw_177, 0xbf53bf11
.set tw_178, 0xbf51bf13
.set tw_179, 0xbf4fbf16
.set tw_180, 0xbf4ebf18
.set tw_181, 0xbf4cbf1b
.set tw_182, 0xbf4abf1d
.set tw_183, 0xbf48bf20
.set tw_184, 0xbf46bf22
.set tw_185, 0xbf44bf25
.set tw_186, 0xbf42bf27
.set tw_187, 0xbf40bf2a
.set tw_188, 0xbf3ebf2c
.set tw_189, 0xbf3cbf2e
.set tw_190, 0xbf39bf31
.set tw_191, 0xbf37bf33
.set tw_192, 0xbf35bf35
.set tw_193, 0xbf33bf37
.set tw_194, 0xbf31bf39
.set tw_195, 0xbf2ebf3c
.set tw_196, 0xbf2cbf3e
.set tw_197, 0xbf2abf40
.set tw_198, 0xbf27bf42
.set tw_199, 0xbf25bf44
.set tw_200, 0xbf22bf46
.set tw_201, 0xbf20bf48
.set tw_202, 0xbf1dbf4a
.set tw_203, 0xbf1bbf4c
.set tw_204, 0xbf18bf4e
.set tw_205, 0xbf16bf4f
.set tw_206, 0xbf13bf51
.set tw_207, 0xbf11bf53
.set tw_208, 0xbf0ebf55
.set tw_209, 0xbf0cbf57
.set tw_210, 0xbf09bf58
.set tw_211, 0xbf06bf5a
.set tw_212, 0xbf04bf5c
.set tw_213, 0xbf01bf5d
.set tw_214, 0xbefcbf5f
.set tw_215, 0xbef7bf60
.set tw_216, 0xbef1bf62
.set tw_217, 0xbeecbf63
.set tw_218, 0xbee6bf65
.set tw_219, 0xbee1bf66
.set tw_220, 0xbedbbf67
.set tw_221, 0xbed5bf69
.set tw_222, 0xbecfbf6a
.set tw_223, 0xbecabf6b
.set tw_224, 0xbec4bf6d
.set tw_225, 0xbebebf6e
.set tw_226, 0xbeb8bf6f
.set tw_227, 0xbeb2bf70
.set tw_228, 0xbeacbf71
.set tw_229, 0xbea7bf72
.set tw_230, 0xbea1bf73
.set tw_231, 0xbe9bbf74
.set tw_232, 0xbe95bf75
.set tw_233, 0xbe8fbf76
.set tw_234, 0xbe89bf77
.set tw_235, 0xbe82bf78
.set tw_236, 0xbe79bf78
.set tw_237, 0xbe6dbf79
.set tw_238, 0xbe60bf7a
.set tw_239, 0xbe54bf7a
.set tw_240, 0xbe48bf7b
.set tw_241, 0xbe3bbf7c
.set tw_242, 0xbe2fbf7c
.set tw_243, 0xbe23bf7d
.set tw_244, 0xbe16bf7d
.set tw_245, 0xbe0abf7e
.set tw_246, 0xbdfbbf7e
.set tw_247, 0xbde2bf7e
.set tw_248, 0xbdc9bf7f
.set tw_249, 0xbdb0bf7f
.set tw_250, 0xbd97bf7f
.set tw_251, 0xbd7bbf80
.set tw_252, 0xbd49bf80
.set tw_253, 0xbd17bf80
.set tw_254, 0xbcc9bf80
.set tw_255, 0xbc49bf80
.set tw_256, 0x0000bf80
.set tw_257, 0x3c49bf80
.set tw_258, 0x3cc9bf80
.set tw_259, 0x3d17bf80
.set tw_260, 0x3d49bf80
.set tw_261, 0x3d7bbf80
.set tw_262, 0x3d97bf7f
.set tw_263, 0x3db0bf7f
.set tw_264, 0x3dc9bf7f
.set tw_265, 0x3de2bf7e
.set tw_266, 0x3dfbbf7e
.set tw_267, 0x3e0abf7e
.set tw_268, 0x3e16bf7d
.set tw_269, 0x3e23bf7d
.set tw_270, 0x3e2fbf7c
.set tw_271, 0x3e3bbf7c
.set tw_272, 0x3e48bf7b
.set tw_273, 0x3e54bf7a
.set tw_274, 0x3e60bf7a
.set tw_275, 0x3e6dbf79
.set tw_276, 0x3e79bf78
.set tw_277, 0x3e82bf78
.set tw_278, 0x3e89bf77
.set tw_279, 0x3e8fbf76
.set tw_280, 0x3e95bf75
.set tw_281, 0x3e9bbf74
.set tw_282, 0x3ea1bf73
.set tw_283, 0x3ea7bf72
.set tw_284, 0x3eacbf71
.set tw_285, 0x3eb2bf70
.set tw_286, 0x3eb8bf6f
.set tw_287, 0x3ebebf6e
.set tw_288, 0x3ec4bf6d
.set tw_289, 0x3ecabf6b
.set tw_290, 0x3ecfbf6a
.set tw_291, 0x3ed5bf69
.set tw_292, 0x3edbbf67
.set tw_293, 0x3ee1bf66
.set tw_294, 0x3ee6bf65
.set tw_295, 0x3eecbf63
.set tw_296, 0x3ef1bf62
.set tw_297, 0x3ef7bf60
.set tw_298, 0x3efcbf5f
.set tw_299, 0x3f01bf5d
.set tw_300, 0x3f04bf5c
.set tw_301, 0x3f06bf5a
.set tw_302, 0x3f09bf58
.set tw_303, 0x3f0cbf57
.set tw_304, 0x3f0ebf55
.set tw_305, 0x3f11bf53
.set tw_306, 0x3f13bf51
.set tw_307, 0x3f16bf4f
.set tw_308, 0x3f18bf4e
.set tw_309, 0x3f1bbf4c
.set tw_310, 0x3f1dbf4a
.set tw_311, 0x3f20bf48
.set tw_312, 0x3f22bf46
.set tw_313, 0x3f25bf44
.set tw_314, 0x3f27bf42
.set tw_315, 0x3f2abf40
.set tw_316, 0x3f2cbf3e
.set tw_317, 0x3f2ebf3c
.set tw_318, 0x3f31bf39
.set tw_319, 0x3f33bf37
.set tw_320, 0x3f35bf35
.set tw_321, 0x3f37bf33
.set tw_322, 0x3f39bf31
.set tw_323, 0x3f3cbf2e
.set tw_324, 0x3f3ebf2c
.set tw_325, 0x3f40bf2a
.set tw_326, 0x3f42bf27
.set tw_327, 0x3f44bf25
.set tw_328, 0x3f46bf22
.set tw_329, 0x3f48bf20
.set tw_330, 0x3f4abf1d
.set tw_331, 0x3f4cbf1b
.set tw_332, 0x3f4ebf18
.set tw_333, 0x3f4fbf16
.set tw_334, 0x3f51bf13
.set tw_335, 0x3f53bf11
.set tw_336, 0x3f55bf0e
.set tw_337, 0x3f57bf0c
.set tw_338, 0x3f58bf09
.set tw_339, 0x3f5abf06
.set tw_340, 0x3f5cbf04
.set tw_341, 0x3f5dbf01
.set tw_342, 0x3f5fbefc
.set tw_343, 0x3f60bef7
.set tw_344, 0x3f62bef1
.set tw_345, 0x3f63beec
.set tw_346, 0x3f65bee6
.set tw_347, 0x3f66bee1
.set tw_348, 0x3f67bedb
.set tw_349, 0x3f69bed5
.set tw_350, 0x3f6abecf
.set tw_351, 0x3f6bbeca
.set tw_352, 0x3f6dbec4
.set tw_353, 0x3f6ebebe
.set tw_354, 0x3f6fbeb8
.set tw_355, 0x3f70beb2
.set tw_356, 0x3f71beac
.set tw_357, 0x3f72bea7
.set tw_358, 0x3f73bea1
.set tw_359, 0x3f74be9b
.set tw_360, 0x3f75be95
.set tw_361, 0x3f76be8f
.set tw_362, 0x3f77be89
.set tw_363, 0x3f78be82
.set tw_364, 0x3f78be79
.set tw_365, 0x3f79be6d
.set tw_366, 0x3f7abe60
.set tw_367, 0x3f7abe54
.set tw_368, 0x3f7bbe48
.set tw_369, 0x3f7cbe3b
.set tw_370, 0x3f7cbe2f
.set tw_371, 0x3f7dbe23
.set tw_372, 0x3f7dbe16
.set tw_373, 0x3f7ebe0a
.set tw_374, 0x3f7ebdfb
.set tw_375, 0x3f7ebde2
.set tw_376, 0x3f7fbdc9
.set tw_377, 0x3f7fbdb0
.set tw_378, 0x3f7fbd97
.set tw_379, 0x3f80bd7b
.set tw_380, 0x3f80bd49
.set tw_381, 0x3f80bd17
.set tw_382, 0x3f80bcc9
.set tw_383, 0x3f80bc49
.set tw_384, 0x3f800000
.set tw_385, 0x3f803c49
.set tw_386, 0x3f803cc9
.set tw_387, 0x3f803d17
.set tw_388, 0x3f803d49
.set tw_389, 0x3f803d7b
.set tw_390, 0x3f7f3d97
.set tw_391, 0x3f7f3db0
.set tw_392, 0x3f7f3dc9
.set tw_393, 0x3f7e3de2
.set tw_394, 0x3f7e3dfb
.set tw_395, 0x3f7e3e0a
.set tw_396, 0x3f7d3e16
.set tw_397, 0x3f7d3e23
.set tw_398, 0x3f7c3e2f
.set tw_399, 0x3f7c3e3b
.set tw_400, 0x3f7b3e48
.set tw_401, 0x3f7a3e54
.set tw_402, 0x3f7a3e60
.set tw_403, 0x3f793e6d
.set tw_404, 0x3f783e79
.set tw_405, 0x3f783e82
.set tw_406, 0x3f773e89
.set tw_407, 0x3f763e8f
.set tw_408, 0x3f753e95
.set tw_409, 0x3f743e9b
.set tw_410, 0x3f733ea1
.set tw_411, 0x3f723ea7
.set tw_412, 0x3f713eac
.set tw_413, 0x3f703eb2
.set tw_414, 0x3f6f3eb8
.set tw_415, 0x3f6e3ebe
.set tw_416, 0x3f6d3ec4
.set tw_417, 0x3f6b3eca
.set tw_418, 0x3f6a3ecf
.set tw_419, 0x3f693ed5
.set tw_420, 0x3f673edb
.set tw_421, 0x3f663ee1
.set tw_422, 0x3f653ee6
.set tw_423, 0x3f633eec
.set tw_424, 0x3f623ef1
.set tw_425, 0x3f603ef7
.set tw_426, 0x3f5f3efc
.set tw_427, 0x3f5d3f01
.set tw_428, 0x3f5c3f04
.set tw_429, 0x3f5a3f06
.set tw_430, 0x3f583f09
.set tw_431, 0x3f573f0c
.set tw_432, 0x3f553f0e
.set tw_433, 0x3f533f11
.set tw_434, 0x3f513f13
.set tw_435, 0x3f4f3f16
.set tw_436, 0x3f4e3f18
.set tw_437, 0x3f4c3f1b
.set tw_438, 0x3f4a3f1d
.set tw_439, 0x3f483f20
.set tw_440, 0x3f463f22
.set tw_441, 0x3f443f25
.set tw_442, 0x3f423f27
.set tw_443, 0x3f403f2a
.set tw_444, 0x3f3e3f2c
.set tw_445, 0x3f3c3f2e
.set tw_446, 0x3f393f31
.set tw_447, 0x3f373f33
.set tw_448, 0x3f353f35
.set tw_449, 0x3f333f37
.set tw_450, 0x3f313f39
.set tw_451, 0x3f2e3f3c
.set tw_452, 0x3f2c3f3e
.set tw_453, 0x3f2a3f40
.set tw_454, 0x3f273f42
.set tw_455, 0x3f253f44
.set tw_456, 0x3f223f46
.set tw_457, 0x3f203f48
.set tw_458, 0x3f1d3f4a
.set tw_459, 0x3f1b3f4c
.set tw_460, 0x3f183f4e
.set tw_461, 0x3f163f4f
.set tw_462, 0x3f133f51
.set tw_463, 0x3f113f53
.set tw_464, 0x3f0e3f55
.set tw_465, 0x3f0c3f57
.set tw_466, 0x3f093f58
.set tw_467, 0x3f063f5a
.set tw_468, 0x3f043f5c
.set tw_469, 0x3f013f5d
.set tw_470, 0x3efc3f5f
.set tw_471, 0x3ef73f60
.set tw_472, 0x3ef13f62
.set tw_473, 0x3eec3f63
.set tw_474, 0x3ee63f65
.set tw_475, 0x3ee13f66
.set tw_476, 0x3edb3f67
.set tw_477, 0x3ed53f69
.set tw_478, 0x3ecf3f6a
.set tw_479, 0x3eca3f6b
.set tw_480, 0x3ec43f6d
.set tw_481, 0x3ebe3f6e
.set tw_482, 0x3eb83f6f
.set tw_483, 0x3eb23f70
.set tw_484, 0x3eac3f71
.set tw_485, 0x3ea73f72
.set tw_486, 0x3ea13f73
.set tw_487, 0x3e9b3f74
.set tw_488, 0x3e953f75
.set tw_489, 0x3e8f3f76
.set tw_490, 0x3e893f77
.set tw_491, 0x3e823f78
.set tw_492, 0x3e793f78
.set tw_493, 0x3e6d3f79
.set tw_494, 0x3e603f7a
.set tw_495, 0x3e543f7a
.set tw_496, 0x3e483f7b
.set tw_497, 0x3e3b3f7c
.set tw_498, 0x3e2f3f7c
.set tw_499, 0x3e233f7d
.set tw_500, 0x3e163f7d
.set tw_501, 0x3e0a3f7e
.set tw_502, 0x3dfb3f7e
.set tw_503, 0x3de23f7e
.set tw_504, 0x3dc93f7f
.set tw_505, 0x3db03f7f
.set tw_506, 0x3d973f7f
.set tw_507, 0x3d7b3f80
.set tw_508, 0x3d493f80
.set tw_509, 0x3d173f80
.set tw_510, 0x3cc93f80
.set tw_511, 0x3c493f80
.macro twe idx
.long tw_\idx
.endm
.altmacro
.p2align 8
ftab:
.set dd, 0
.rept 512
.long 0x3f003f00 | ((dd & 1) << 31)
.set kk, 1
.rept 255
twe %((dd*kk) & 511)
.set kk, kk+1
.endr
.fill 32, 4, 0
.set dd, dd+1
.endr
.noaltmacro
```
